```python
import torch

def _softmax(x, axis=-1):
    return torch.softmax(x, dim=axis)
def _gelu(x):
    return torch.nn.functional.gelu(x, approximate="tanh")
def _silu(x):
    return torch.nn.functional.silu(x)
def _sigmoid(x):
    return torch.sigmoid(x)
def _layernorm(x, axis=-1, eps=1e-5):
    m = x.mean(dim=axis, keepdim=True)
    v = x.var(dim=axis, keepdim=True, unbiased=False)
    return (x - m) / torch.sqrt(v + eps)
def _scatter_add(tgt, idx, src, axis=0):
    return tgt.clone().index_add_(axis, idx, src)
def _segment_sum(src, seg, n):
    out = torch.zeros((n,) + src.shape[1:], dtype=src.dtype)
    return out.index_add_(0, seg, src)
def _pad(x, pw):
    flat = tuple(v for pair in reversed(pw) for v in pair)
    return torch.nn.functional.pad(x, flat)

kernel_name = 'standalone__sliding_block_cached__sampling'

def setup_inputs():

    _w = (lambda a: (lambda t: t.to(torch.bfloat16) if t.is_floating_point() else t)(torch.as_tensor(a)))
    B, Sq, D = 8, 32, 1024
    Hq, Hkv, Sk, Dh = 32, 4, 8192, 128
    assert Hq % Hkv == 0, (Hq, Hkv)
    return {
        "x": _w((lambda *s: torch.randn(*s, dtype=torch.bfloat16) * 0.8)(B, Sq, D)),
        "k_cache": _w((lambda *s: torch.randn(*s, dtype=torch.bfloat16) * 0.8)(B, Hkv, Sk, Dh)),
        "v_cache": _w((lambda *s: torch.randn(*s, dtype=torch.bfloat16) * 0.05)(B, Hkv, Sk, Dh)),
        "wq": _w((lambda *s: torch.randn(*s, dtype=torch.bfloat16) * 0.8)(D, Hq * Dh) * (D ** -0.5)),
        "wo": _w((lambda *s: torch.randn(*s, dtype=torch.bfloat16) * 0.05)(Hq * Dh, D) * ((Hq * Dh) ** -0.5)),
    }

def reference(x, k_cache, v_cache, wq, wo):
    B, Sq, D = x.shape
    Hq, Dh = 32, 128
    Hkv, Sk = k_cache.shape[1], k_cache.shape[2]
    W = min(4096, max(256, Sk // 4))
    rep = Hq // Hkv
    q = (lambda x, *d: x.permute(*d))((x @ wq).reshape(B, Sq, Hq, Dh), 0, 2, 1, 3)
    k = (lambda x, n, axis: torch.repeat_interleave(x, n, dim=axis))(k_cache[:, :, Sk - W:, :], rep, axis=1)
    v = (lambda x, n, axis: torch.repeat_interleave(x, n, dim=axis))(v_cache[:, :, Sk - W:, :], rep, axis=1)
    scores = torch.einsum("bhqd,bhkd->bhqk", q, k) * (Dh ** -0.5)
    p = _softmax(scores, axis=-1)
    o = torch.einsum("bhqk,bhkd->bhqd", p, v)
    return (lambda x, *d: x.permute(*d))(o, 0, 2, 1, 3).reshape(B, Sq, Hq * Dh) @ wo
```

```asm
; @launch grid=(256,1,1) block=(512,1,1) lds=163840
.amdgcn_target "amdgcn-amd-amdhsa--gfx950"
.text
.globl standalone__sliding_block_cached__sampling_kernel
.p2align 8
.type standalone__sliding_block_cached__sampling_kernel,@function
standalone__sliding_block_cached__sampling_kernel:
  s_cmp_ge_u32 s2, 256
  s_cbranch_scc1 L_END
  s_load_dwordx16 s[16:31], s[0:1], 0
  s_and_b32 s3, s2, 7
  s_lshr_b32 s4, s2, 3
  v_lshrrev_b32 v1, 6, v0
  s_getpc_b64 s[72:73]
L_PC:
  s_and_b32 s8, s2, 0xf8
  v_add_u32 v2, s8, v1
  v_lshlrev_b32 v2, 7, v2
  v_min_u32 v2, L_CODE_END-L_PC-128, v2
  v_and_b32 v3, 31, v0
  v_lshl_add_u32 v2, v3, 2, v2
  global_load_dword v176, v2, s[72:73]
  v_and_b32 v0, 63, v0
  v_readfirstlane_b32 s5, v1
  v_lshlrev_b32 v1, 4, v0
  s_and_b32 s8, s4, 7
  s_lshl_b32 s66, s3, 3
  s_add_u32 s66, s66, s8
  s_lshr_b32 s67, s4, 3
  s_lshl_b32 s74, s67, 1
  s_add_u32 s74, s74, s8
  s_lshl_b32 s14, s3, 2
  s_add_u32 s14, s14, s67
  s_and_b32 s15, s4, 3
  s_bfe_u32 s68, s4, 0x10002
  s_lshl_b32 s75, s14, 1
  s_add_u32 s75, s75, s68
  s_and_b32 s6, s5, 3
  s_lshr_b32 s7, s5, 2
  s_lshl_b32 s13, s6, 10
  s_lshr_b32 s97, s3, 1
  s_and_b32 s96, s3, 1
  s_lshl_b32 s96, s96, 3
  s_add_u32 s96, s96, s8
  s_cmp_eq_u32 s7, 0
  s_cbranch_scc1 L_CWAVE
  v_lshrrev_b32 v21, 4, v0
  s_lshl_b32 s9, s6, 2
  v_add_u32 v22, s9, v21
  v_and_b32 v23, 15, v0
  v_xor_b32 v24, v23, v22
  v_lshlrev_b32 v24, 4, v24
  v_lshl_add_u32 v16, v22, 11, v24
  v_lshrrev_b32 v25, 3, v0
  v_and_b32 v26, 7, v0
  v_lshlrev_b32 v27, 1, v25
  v_and_b32 v27, 4, v27
  v_xor_b32 v26, v26, v27
  v_lshlrev_b32 v26, 4, v26
  v_lshl_add_u32 v17, v25, 13, v26
  s_lshl_b32 s64, s67, 17
  s_lshl_b32 s65, s66, 7
  s_lshl_b32 s9, s6, 16
  s_add_u32 s65, s65, s9
  s_mov_b32 s46, 0x800000
  s_mov_b32 s47, 0x20000
  s_mov_b32 s34, 0x80000
  s_mov_b32 s35, 0x20000
  s_waitcnt lgkmcnt(0)
  s_mov_b32 s44, s22
  s_and_b32 s45, s23, 0xffff
  s_mov_b32 s32, s16
  s_and_b32 s33, s17, 0xffff
  s_add_u32 s9, s74, 0
  s_and_b32 s9, s9, 7
  s_lshl_b32 s10, s9, 20
  s_add_u32 s10, s10, s65
  s_lshl_b32 s11, s9, 8
  s_add_u32 s11, s11, s64
  s_add_u32 m0, s13, 0xc000
  s_add_u32 s8, s10, 0x0
  buffer_load_dwordx4 v17, s[44:47], s8 offen lds
  s_add_u32 m0, s13, 0x8000
  s_add_u32 s8, s11, 0x0
  buffer_load_dwordx4 v16, s[32:35], s8 offen lds
  s_add_u32 m0, s13, 0xd000
  s_add_u32 s8, s10, 0x40000
  buffer_load_dwordx4 v17, s[44:47], s8 offen lds
  s_add_u32 m0, s13, 0x9000
  s_add_u32 s8, s11, 0x8000
  buffer_load_dwordx4 v16, s[32:35], s8 offen lds
  s_add_u32 m0, s13, 0xe000
  s_add_u32 s8, s10, 0x80000
  buffer_load_dwordx4 v17, s[44:47], s8 offen lds
  s_add_u32 m0, s13, 0xa000
  s_add_u32 s8, s11, 0x10000
  buffer_load_dwordx4 v16, s[32:35], s8 offen lds
  s_add_u32 m0, s13, 0xf000
  s_add_u32 s8, s10, 0xc0000
  buffer_load_dwordx4 v17, s[44:47], s8 offen lds
  s_add_u32 m0, s13, 0xb000
  s_add_u32 s8, s11, 0x18000
  buffer_load_dwordx4 v16, s[32:35], s8 offen lds
  s_add_u32 s9, s74, 1
  s_and_b32 s9, s9, 7
  s_lshl_b32 s10, s9, 20
  s_add_u32 s10, s10, s65
  s_lshl_b32 s11, s9, 8
  s_add_u32 s11, s11, s64
  s_add_u32 m0, s13, 0x14000
  s_add_u32 s8, s10, 0x0
  buffer_load_dwordx4 v17, s[44:47], s8 offen lds
  s_add_u32 m0, s13, 0x10000
  s_add_u32 s8, s11, 0x0
  buffer_load_dwordx4 v16, s[32:35], s8 offen lds
  s_add_u32 m0, s13, 0x15000
  s_add_u32 s8, s10, 0x40000
  buffer_load_dwordx4 v17, s[44:47], s8 offen lds
  s_add_u32 m0, s13, 0x11000
  s_add_u32 s8, s11, 0x8000
  buffer_load_dwordx4 v16, s[32:35], s8 offen lds
  s_add_u32 m0, s13, 0x16000
  s_add_u32 s8, s10, 0x80000
  buffer_load_dwordx4 v17, s[44:47], s8 offen lds
  s_add_u32 m0, s13, 0x12000
  s_add_u32 s8, s11, 0x10000
  buffer_load_dwordx4 v16, s[32:35], s8 offen lds
  s_add_u32 m0, s13, 0x17000
  s_add_u32 s8, s10, 0xc0000
  buffer_load_dwordx4 v17, s[44:47], s8 offen lds
  s_add_u32 m0, s13, 0x13000
  s_add_u32 s8, s11, 0x18000
  buffer_load_dwordx4 v16, s[32:35], s8 offen lds
  s_mov_b32 s36, s18
  s_and_b32 s37, s19, 0xffff
  s_mov_b32 s38, 0x4000000
  s_mov_b32 s39, 0x20000
  s_mov_b32 s40, s20
  s_and_b32 s41, s21, 0xffff
  s_mov_b32 s42, 0x4000000
  s_mov_b32 s43, 0x20000
  s_mov_b32 s48, s24
  s_and_b32 s49, s25, 0xffff
  s_mov_b32 s50, 0x800000
  s_mov_b32 s51, 0x20000
  s_mov_b32 s52, s26
  s_and_b32 s53, s27, 0xffff
  s_mov_b32 s54, 0x80000
  s_mov_b32 s55, 0x20000
  s_mov_b32 s60, s30
  s_and_b32 s61, s31, 0xffff
  s_mov_b32 s62, 0x10000000
  s_mov_b32 s63, 0x20000
  v_lshl_add_u32 v18, v22, 8, v24
  v_and_b32 v28, 7, v22
  v_lshlrev_b32 v28, 1, v28
  v_xor_b32 v28, v23, v28
  v_lshlrev_b32 v28, 4, v28
  v_lshl_add_u32 v19, v22, 8, v28
  v_lshl_add_u32 v20, v25, 11, v26
  s_lshl_b32 s69, s14, 21
  s_add_u32 s69, s69, 0x180000
  s_lshl_b32 s66, s97, 21
  s_lshl_b32 s9, s6, 14
  s_add_u32 s66, s66, s9
  s_lshl_b32 s9, s4, 16
  s_add_u32 s66, s66, s9
  s_and_b32 s9, s3, 1
  s_lshl_b32 s9, s9, 10
  s_add_u32 s66, s66, s9
  s_load_dword s79, s[18:19], 0
  s_load_dword s79, s[20:21], 0
  s_load_dword s79, s[24:25], 0
  s_load_dword s79, s[26:27], 0
  v_mov_b32 v43, 0
  s_mov_b64 exec, 1
  buffer_load_dword v44, v43, s[52:55], 0 offen
  buffer_load_dword v44, v43, s[60:63], 0 offen
  s_mov_b64 exec, -1
  v_mov_b32 v40, 0
  s_lshl_b32 s9, s75, 2
  s_add_u32 s9, s9, s6
  s_mul_i32 s9, s9, 1152
  s_add_u32 s9, s9, 0x2000000
  s_add_u32 s72, s60, s9
  s_addc_u32 s73, s61, 0
  s_load_dword s78, s[72:73], 0 glc
  s_mov_b32 s9, s75
  s_mul_i32 s9, s9, 1152
  s_add_u32 s9, s9, 0x2200000
  s_add_u32 s72, s60, s9
  s_addc_u32 s73, s61, 0
  s_load_dword s78, s[72:73], 0 glc
  s_lshl_b32 s9, s67, 3
  s_add_u32 s9, s9, s97
  s_lshl_b32 s9, s9, 5
  s_add_u32 s9, s9, s96
  s_and_b32 s10, s6, 1
  s_lshl_b32 s10, s10, 7
  s_add_u32 s9, s9, s10
  s_lshr_b32 s10, s6, 1
  s_lshl_b32 s10, s10, 4
  s_add_u32 s9, s9, s10
  s_mul_i32 s9, s9, 1152
  s_add_u32 s9, s9, 0x2300000
  s_add_u32 s72, s60, s9
  s_addc_u32 s73, s61, 0
  s_load_dword s78, s[72:73], 0 glc
  s_lshl_b32 s9, s67, 4
  s_add_u32 s9, s9, s96
  s_lshl_b32 s9, s9, 2
  s_add_u32 s9, s9, s97
  s_lshl_b32 s9, s9, 1
  s_and_b32 s10, s6, 1
  s_add_u32 s9, s9, s10
  s_mul_i32 s9, s9, 1152
  s_add_u32 s9, s9, 0x2800000
  s_add_u32 s72, s60, s9
  s_addc_u32 s73, s61, 0
  s_load_dword s78, s[72:73], 0 glc
  s_waitcnt vmcnt(10)
  s_barrier
  s_add_u32 s9, s74, 2
  s_and_b32 s9, s9, 7
  s_lshl_b32 s10, s9, 20
  s_add_u32 s10, s10, s65
  s_lshl_b32 s11, s9, 8
  s_add_u32 s11, s11, s64
  s_add_u32 m0, s13, 0x1c000
  s_add_u32 s8, s10, 0x0
  buffer_load_dwordx4 v17, s[44:47], s8 offen lds
  s_add_u32 m0, s13, 0x18000
  s_add_u32 s8, s11, 0x0
  buffer_load_dwordx4 v16, s[32:35], s8 offen lds
  s_add_u32 m0, s13, 0x1d000
  s_add_u32 s8, s10, 0x40000
  buffer_load_dwordx4 v17, s[44:47], s8 offen lds
  s_add_u32 m0, s13, 0x19000
  s_add_u32 s8, s11, 0x8000
  buffer_load_dwordx4 v16, s[32:35], s8 offen lds
  s_add_u32 m0, s13, 0x1e000
  s_add_u32 s8, s10, 0x80000
  buffer_load_dwordx4 v17, s[44:47], s8 offen lds
  s_add_u32 m0, s13, 0x1a000
  s_add_u32 s8, s11, 0x10000
  buffer_load_dwordx4 v16, s[32:35], s8 offen lds
  s_add_u32 m0, s13, 0x1f000
  s_add_u32 s8, s10, 0xc0000
  buffer_load_dwordx4 v17, s[44:47], s8 offen lds
  s_add_u32 m0, s13, 0x1b000
  s_add_u32 s8, s11, 0x18000
  buffer_load_dwordx4 v16, s[32:35], s8 offen lds
  s_waitcnt vmcnt(10)
  s_barrier
  s_add_u32 s9, s74, 3
  s_and_b32 s9, s9, 7
  s_lshl_b32 s10, s9, 20
  s_add_u32 s10, s10, s65
  s_lshl_b32 s11, s9, 8
  s_add_u32 s11, s11, s64
  s_add_u32 m0, s13, 0x24000
  s_add_u32 s8, s10, 0x0
  buffer_load_dwordx4 v17, s[44:47], s8 offen lds
  s_add_u32 m0, s13, 0x20000
  s_add_u32 s8, s11, 0x0
  buffer_load_dwordx4 v16, s[32:35], s8 offen lds
  s_add_u32 m0, s13, 0x25000
  s_add_u32 s8, s10, 0x40000
  buffer_load_dwordx4 v17, s[44:47], s8 offen lds
  s_add_u32 m0, s13, 0x21000
  s_add_u32 s8, s11, 0x8000
  buffer_load_dwordx4 v16, s[32:35], s8 offen lds
  s_add_u32 m0, s13, 0x26000
  s_add_u32 s8, s10, 0x80000
  buffer_load_dwordx4 v17, s[44:47], s8 offen lds
  s_add_u32 m0, s13, 0x22000
  s_add_u32 s8, s11, 0x10000
  buffer_load_dwordx4 v16, s[32:35], s8 offen lds
  s_add_u32 m0, s13, 0x27000
  s_add_u32 s8, s10, 0xc0000
  buffer_load_dwordx4 v17, s[44:47], s8 offen lds
  s_add_u32 m0, s13, 0x23000
  s_add_u32 s8, s11, 0x18000
  buffer_load_dwordx4 v16, s[32:35], s8 offen lds
  s_waitcnt vmcnt(8)
  s_barrier
  s_add_u32 s9, s74, 4
  s_and_b32 s9, s9, 7
  s_lshl_b32 s10, s9, 20
  s_add_u32 s10, s10, s65
  s_lshl_b32 s11, s9, 8
  s_add_u32 s11, s11, s64
  s_add_u32 m0, s13, 0xc000
  s_add_u32 s8, s10, 0x0
  buffer_load_dwordx4 v17, s[44:47], s8 offen lds
  s_add_u32 m0, s13, 0x8000
  s_add_u32 s8, s11, 0x0
  buffer_load_dwordx4 v16, s[32:35], s8 offen lds
  s_add_u32 m0, s13, 0xd000
  s_add_u32 s8, s10, 0x40000
  buffer_load_dwordx4 v17, s[44:47], s8 offen lds
  s_add_u32 m0, s13, 0x9000
  s_add_u32 s8, s11, 0x8000
  buffer_load_dwordx4 v16, s[32:35], s8 offen lds
  s_add_u32 m0, s13, 0xe000
  s_add_u32 s8, s10, 0x80000
  buffer_load_dwordx4 v17, s[44:47], s8 offen lds
  s_add_u32 m0, s13, 0xa000
  s_add_u32 s8, s11, 0x10000
  buffer_load_dwordx4 v16, s[32:35], s8 offen lds
  s_add_u32 m0, s13, 0xf000
  s_add_u32 s8, s10, 0xc0000
  buffer_load_dwordx4 v17, s[44:47], s8 offen lds
  s_add_u32 m0, s13, 0xb000
  s_add_u32 s8, s11, 0x18000
  buffer_load_dwordx4 v16, s[32:35], s8 offen lds
  s_waitcnt vmcnt(8)
  s_barrier
  s_add_u32 s9, s74, 5
  s_and_b32 s9, s9, 7
  s_lshl_b32 s10, s9, 20
  s_add_u32 s10, s10, s65
  s_lshl_b32 s11, s9, 8
  s_add_u32 s11, s11, s64
  s_add_u32 m0, s13, 0x14000
  s_add_u32 s8, s10, 0x0
  buffer_load_dwordx4 v17, s[44:47], s8 offen lds
  s_add_u32 m0, s13, 0x10000
  s_add_u32 s8, s11, 0x0
  buffer_load_dwordx4 v16, s[32:35], s8 offen lds
  s_add_u32 m0, s13, 0x15000
  s_add_u32 s8, s10, 0x40000
  buffer_load_dwordx4 v17, s[44:47], s8 offen lds
  s_add_u32 m0, s13, 0x11000
  s_add_u32 s8, s11, 0x8000
  buffer_load_dwordx4 v16, s[32:35], s8 offen lds
  s_add_u32 m0, s13, 0x16000
  s_add_u32 s8, s10, 0x80000
  buffer_load_dwordx4 v17, s[44:47], s8 offen lds
  s_add_u32 m0, s13, 0x12000
  s_add_u32 s8, s11, 0x10000
  buffer_load_dwordx4 v16, s[32:35], s8 offen lds
  s_add_u32 m0, s13, 0x17000
  s_add_u32 s8, s10, 0xc0000
  buffer_load_dwordx4 v17, s[44:47], s8 offen lds
  s_add_u32 m0, s13, 0x13000
  s_add_u32 s8, s11, 0x18000
  buffer_load_dwordx4 v16, s[32:35], s8 offen lds
  s_waitcnt vmcnt(8)
  s_barrier
  s_add_u32 s9, s74, 6
  s_and_b32 s9, s9, 7
  s_lshl_b32 s10, s9, 20
  s_add_u32 s10, s10, s65
  s_lshl_b32 s11, s9, 8
  s_add_u32 s11, s11, s64
  s_add_u32 m0, s13, 0x1c000
  s_add_u32 s8, s10, 0x0
  buffer_load_dwordx4 v17, s[44:47], s8 offen lds
  s_add_u32 m0, s13, 0x18000
  s_add_u32 s8, s11, 0x0
  buffer_load_dwordx4 v16, s[32:35], s8 offen lds
  s_add_u32 m0, s13, 0x1d000
  s_add_u32 s8, s10, 0x40000
  buffer_load_dwordx4 v17, s[44:47], s8 offen lds
  s_add_u32 m0, s13, 0x19000
  s_add_u32 s8, s11, 0x8000
  buffer_load_dwordx4 v16, s[32:35], s8 offen lds
  s_add_u32 m0, s13, 0x1e000
  s_add_u32 s8, s10, 0x80000
  buffer_load_dwordx4 v17, s[44:47], s8 offen lds
  s_add_u32 m0, s13, 0x1a000
  s_add_u32 s8, s11, 0x10000
  buffer_load_dwordx4 v16, s[32:35], s8 offen lds
  s_add_u32 m0, s13, 0x1f000
  s_add_u32 s8, s10, 0xc0000
  buffer_load_dwordx4 v17, s[44:47], s8 offen lds
  s_add_u32 m0, s13, 0x1b000
  s_add_u32 s8, s11, 0x18000
  buffer_load_dwordx4 v16, s[32:35], s8 offen lds
  s_waitcnt vmcnt(8)
  s_barrier
  s_add_u32 s9, s74, 7
  s_and_b32 s9, s9, 7
  s_lshl_b32 s10, s9, 20
  s_add_u32 s10, s10, s65
  s_lshl_b32 s11, s9, 8
  s_add_u32 s11, s11, s64
  s_add_u32 m0, s13, 0x24000
  s_add_u32 s8, s10, 0x0
  buffer_load_dwordx4 v17, s[44:47], s8 offen lds
  s_add_u32 m0, s13, 0x20000
  s_add_u32 s8, s11, 0x0
  buffer_load_dwordx4 v16, s[32:35], s8 offen lds
  s_add_u32 m0, s13, 0x25000
  s_add_u32 s8, s10, 0x40000
  buffer_load_dwordx4 v17, s[44:47], s8 offen lds
  s_add_u32 m0, s13, 0x21000
  s_add_u32 s8, s11, 0x8000
  buffer_load_dwordx4 v16, s[32:35], s8 offen lds
  s_add_u32 m0, s13, 0x26000
  s_add_u32 s8, s10, 0x80000
  buffer_load_dwordx4 v17, s[44:47], s8 offen lds
  s_add_u32 m0, s13, 0x22000
  s_add_u32 s8, s11, 0x10000
  buffer_load_dwordx4 v16, s[32:35], s8 offen lds
  s_add_u32 m0, s13, 0x27000
  s_add_u32 s8, s10, 0xc0000
  buffer_load_dwordx4 v17, s[44:47], s8 offen lds
  s_add_u32 m0, s13, 0x23000
  s_add_u32 s8, s11, 0x18000
  buffer_load_dwordx4 v16, s[32:35], s8 offen lds
  s_lshl_b32 s9, s15, 14
  s_add_u32 s9, s9, 0
  s_add_u32 s9, s9, s69
  s_add_u32 m0, s13, 0x0
  s_add_u32 s8, s9, 0x0
  buffer_load_dwordx4 v18, s[36:39], s8 offen nt lds
  s_add_u32 m0, s13, 0x1000
  s_add_u32 s8, s9, 0x1000
  buffer_load_dwordx4 v18, s[36:39], s8 offen nt lds
  s_add_u32 m0, s13, 0x2000
  s_add_u32 s8, s9, 0x2000
  buffer_load_dwordx4 v18, s[36:39], s8 offen nt lds
  s_add_u32 m0, s13, 0x3000
  s_add_u32 s8, s9, 0x3000
  buffer_load_dwordx4 v18, s[36:39], s8 offen nt lds
  s_waitcnt vmcnt(12)
  s_barrier
  s_lshl_b32 s9, s15, 14
  s_add_u32 s9, s9, 65536
  s_add_u32 s9, s9, s69
  s_add_u32 m0, s13, 0x8000
  s_add_u32 s8, s9, 0x0
  buffer_load_dwordx4 v18, s[36:39], s8 offen nt lds
  s_add_u32 m0, s13, 0x9000
  s_add_u32 s8, s9, 0x1000
  buffer_load_dwordx4 v18, s[36:39], s8 offen nt lds
  s_add_u32 m0, s13, 0xa000
  s_add_u32 s8, s9, 0x2000
  buffer_load_dwordx4 v18, s[36:39], s8 offen nt lds
  s_add_u32 m0, s13, 0xb000
  s_add_u32 s8, s9, 0x3000
  buffer_load_dwordx4 v18, s[36:39], s8 offen nt lds
  s_lshl_b32 s9, s15, 14
  s_add_u32 s9, s9, 0
  s_add_u32 s9, s9, s69
  s_add_u32 m0, s13, 0x4000
  s_add_u32 s8, s9, 0x0
  buffer_load_dwordx4 v19, s[40:43], s8 offen nt lds
  s_add_u32 m0, s13, 0x5000
  s_add_u32 s8, s9, 0x1000
  buffer_load_dwordx4 v19, s[40:43], s8 offen nt lds
  s_add_u32 m0, s13, 0x6000
  s_add_u32 s8, s9, 0x2000
  buffer_load_dwordx4 v19, s[40:43], s8 offen nt lds
  s_add_u32 m0, s13, 0x7000
  s_add_u32 s8, s9, 0x3000
  buffer_load_dwordx4 v19, s[40:43], s8 offen nt lds
  s_waitcnt vmcnt(12)
  s_barrier
  s_load_dwordx2 s[70:71], s[28:29], 0
  s_lshl_b32 s64, s97, 21
  s_lshl_b32 s9, s6, 14
  s_add_u32 s64, s64, s9
  s_lshl_b32 s9, s96, 7
  s_add_u32 s64, s64, s9
  s_mov_b32 s12, 0
NON_1:
  s_waitcnt lgkmcnt(0)
  s_cmp_lg_u32 s70, 0
  s_cbranch_scc1 NOND_2
  s_add_u32 s12, s12, 1
  s_cmp_ge_u32 s12, 0x200000
  s_cbranch_scc1 NOND_2
  s_sleep 8
  s_load_dwordx2 s[70:71], s[28:29], 0 glc
  s_branch NON_1
NOND_2:
  v_mov_b32 v250, s70
  v_mov_b32 v251, s71
  s_barrier
  s_lshl_b32 s9, s15, 14
  s_add_u32 s9, s9, 131072
  s_add_u32 s9, s9, s69
  s_add_u32 m0, s13, 0x10000
  s_add_u32 s8, s9, 0x0
  buffer_load_dwordx4 v18, s[36:39], s8 offen nt lds
  s_add_u32 m0, s13, 0x11000
  s_add_u32 s8, s9, 0x1000
  buffer_load_dwordx4 v18, s[36:39], s8 offen nt lds
  s_add_u32 m0, s13, 0x12000
  s_add_u32 s8, s9, 0x2000
  buffer_load_dwordx4 v18, s[36:39], s8 offen nt lds
  s_add_u32 m0, s13, 0x13000
  s_add_u32 s8, s9, 0x3000
  buffer_load_dwordx4 v18, s[36:39], s8 offen nt lds
  s_barrier
  s_waitcnt vmcnt(12)
  s_barrier
  s_lshl_b32 s9, s15, 14
  s_add_u32 s9, s9, 65536
  s_add_u32 s9, s9, s69
  s_add_u32 m0, s13, 0xc000
  s_add_u32 s8, s9, 0x0
  buffer_load_dwordx4 v19, s[40:43], s8 offen nt lds
  s_add_u32 m0, s13, 0xd000
  s_add_u32 s8, s9, 0x1000
  buffer_load_dwordx4 v19, s[40:43], s8 offen nt lds
  s_add_u32 m0, s13, 0xe000
  s_add_u32 s8, s9, 0x2000
  buffer_load_dwordx4 v19, s[40:43], s8 offen nt lds
  s_add_u32 m0, s13, 0xf000
  s_add_u32 s8, s9, 0x3000
  buffer_load_dwordx4 v19, s[40:43], s8 offen nt lds
  s_lshl_b32 s9, s15, 14
  s_add_u32 s9, s9, 196608
  s_add_u32 s9, s9, s69
  s_add_u32 m0, s13, 0x18000
  s_add_u32 s8, s9, 0x0
  buffer_load_dwordx4 v18, s[36:39], s8 offen nt lds
  s_add_u32 m0, s13, 0x19000
  s_add_u32 s8, s9, 0x1000
  buffer_load_dwordx4 v18, s[36:39], s8 offen nt lds
  s_add_u32 m0, s13, 0x1a000
  s_add_u32 s8, s9, 0x2000
  buffer_load_dwordx4 v18, s[36:39], s8 offen nt lds
  s_add_u32 m0, s13, 0x1b000
  s_add_u32 s8, s9, 0x3000
  buffer_load_dwordx4 v18, s[36:39], s8 offen nt lds
  s_lshl_b32 s9, s15, 14
  s_add_u32 s9, s9, 131072
  s_add_u32 s9, s9, s69
  s_add_u32 m0, s13, 0x14000
  s_add_u32 s8, s9, 0x0
  buffer_load_dwordx4 v19, s[40:43], s8 offen nt lds
  s_add_u32 m0, s13, 0x15000
  s_add_u32 s8, s9, 0x1000
  buffer_load_dwordx4 v19, s[40:43], s8 offen nt lds
  s_add_u32 m0, s13, 0x16000
  s_add_u32 s8, s9, 0x2000
  buffer_load_dwordx4 v19, s[40:43], s8 offen nt lds
  s_add_u32 m0, s13, 0x17000
  s_add_u32 s8, s9, 0x3000
  buffer_load_dwordx4 v19, s[40:43], s8 offen nt lds
  s_waitcnt vmcnt(16)
  s_barrier
  s_lshl_b32 s9, s15, 14
  s_add_u32 s9, s9, 262144
  s_add_u32 s9, s9, s69
  s_add_u32 m0, s13, 0x20000
  s_add_u32 s8, s9, 0x0
  buffer_load_dwordx4 v18, s[36:39], s8 offen nt lds
  s_add_u32 m0, s13, 0x21000
  s_add_u32 s8, s9, 0x1000
  buffer_load_dwordx4 v18, s[36:39], s8 offen nt lds
  s_add_u32 m0, s13, 0x22000
  s_add_u32 s8, s9, 0x2000
  buffer_load_dwordx4 v18, s[36:39], s8 offen nt lds
  s_add_u32 m0, s13, 0x23000
  s_add_u32 s8, s9, 0x3000
  buffer_load_dwordx4 v18, s[36:39], s8 offen nt lds
  s_lshl_b32 s9, s15, 14
  s_add_u32 s9, s9, 196608
  s_add_u32 s9, s9, s69
  s_add_u32 m0, s13, 0x1c000
  s_add_u32 s8, s9, 0x0
  buffer_load_dwordx4 v19, s[40:43], s8 offen nt lds
  s_add_u32 m0, s13, 0x1d000
  s_add_u32 s8, s9, 0x1000
  buffer_load_dwordx4 v19, s[40:43], s8 offen nt lds
  s_add_u32 m0, s13, 0x1e000
  s_add_u32 s8, s9, 0x2000
  buffer_load_dwordx4 v19, s[40:43], s8 offen nt lds
  s_add_u32 m0, s13, 0x1f000
  s_add_u32 s8, s9, 0x3000
  buffer_load_dwordx4 v19, s[40:43], s8 offen nt lds
  s_waitcnt vmcnt(16)
  s_barrier
  s_lshl_b32 s9, s15, 14
  s_add_u32 s9, s9, 327680
  s_add_u32 s9, s9, s69
  s_add_u32 m0, s13, 0x0
  s_add_u32 s8, s9, 0x0
  buffer_load_dwordx4 v18, s[36:39], s8 offen nt lds
  s_add_u32 m0, s13, 0x1000
  s_add_u32 s8, s9, 0x1000
  buffer_load_dwordx4 v18, s[36:39], s8 offen nt lds
  s_add_u32 m0, s13, 0x2000
  s_add_u32 s8, s9, 0x2000
  buffer_load_dwordx4 v18, s[36:39], s8 offen nt lds
  s_add_u32 m0, s13, 0x3000
  s_add_u32 s8, s9, 0x3000
  buffer_load_dwordx4 v18, s[36:39], s8 offen nt lds
  s_lshl_b32 s9, s15, 14
  s_add_u32 s9, s9, 262144
  s_add_u32 s9, s9, s69
  s_add_u32 m0, s13, 0x24000
  s_add_u32 s8, s9, 0x0
  buffer_load_dwordx4 v19, s[40:43], s8 offen nt lds
  s_add_u32 m0, s13, 0x25000
  s_add_u32 s8, s9, 0x1000
  buffer_load_dwordx4 v19, s[40:43], s8 offen nt lds
  s_add_u32 m0, s13, 0x26000
  s_add_u32 s8, s9, 0x2000
  buffer_load_dwordx4 v19, s[40:43], s8 offen nt lds
  s_add_u32 m0, s13, 0x27000
  s_add_u32 s8, s9, 0x3000
  buffer_load_dwordx4 v19, s[40:43], s8 offen nt lds
  s_waitcnt vmcnt(16)
  s_barrier
  s_lshl_b32 s9, s15, 14
  s_add_u32 s9, s9, 393216
  s_add_u32 s9, s9, s69
  s_add_u32 m0, s13, 0x8000
  s_add_u32 s8, s9, 0x0
  buffer_load_dwordx4 v18, s[36:39], s8 offen nt lds
  s_add_u32 m0, s13, 0x9000
  s_add_u32 s8, s9, 0x1000
  buffer_load_dwordx4 v18, s[36:39], s8 offen nt lds
  s_add_u32 m0, s13, 0xa000
  s_add_u32 s8, s9, 0x2000
  buffer_load_dwordx4 v18, s[36:39], s8 offen nt lds
  s_add_u32 m0, s13, 0xb000
  s_add_u32 s8, s9, 0x3000
  buffer_load_dwordx4 v18, s[36:39], s8 offen nt lds
  s_lshl_b32 s9, s15, 14
  s_add_u32 s9, s9, 327680
  s_add_u32 s9, s9, s69
  s_add_u32 m0, s13, 0x4000
  s_add_u32 s8, s9, 0x0
  buffer_load_dwordx4 v19, s[40:43], s8 offen nt lds
  s_add_u32 m0, s13, 0x5000
  s_add_u32 s8, s9, 0x1000
  buffer_load_dwordx4 v19, s[40:43], s8 offen nt lds
  s_add_u32 m0, s13, 0x6000
  s_add_u32 s8, s9, 0x2000
  buffer_load_dwordx4 v19, s[40:43], s8 offen nt lds
  s_add_u32 m0, s13, 0x7000
  s_add_u32 s8, s9, 0x3000
  buffer_load_dwordx4 v19, s[40:43], s8 offen nt lds
  s_waitcnt vmcnt(16)
  s_barrier
  s_lshl_b32 s9, s15, 14
  s_add_u32 s9, s9, 458752
  s_add_u32 s9, s9, s69
  s_add_u32 m0, s13, 0x10000
  s_add_u32 s8, s9, 0x0
  buffer_load_dwordx4 v18, s[36:39], s8 offen nt lds
  s_add_u32 m0, s13, 0x11000
  s_add_u32 s8, s9, 0x1000
  buffer_load_dwordx4 v18, s[36:39], s8 offen nt lds
  s_add_u32 m0, s13, 0x12000
  s_add_u32 s8, s9, 0x2000
  buffer_load_dwordx4 v18, s[36:39], s8 offen nt lds
  s_add_u32 m0, s13, 0x13000
  s_add_u32 s8, s9, 0x3000
  buffer_load_dwordx4 v18, s[36:39], s8 offen nt lds
  s_lshl_b32 s9, s15, 14
  s_add_u32 s9, s9, 393216
  s_add_u32 s9, s9, s69
  s_add_u32 m0, s13, 0xc000
  s_add_u32 s8, s9, 0x0
  buffer_load_dwordx4 v19, s[40:43], s8 offen nt lds
  s_add_u32 m0, s13, 0xd000
  s_add_u32 s8, s9, 0x1000
  buffer_load_dwordx4 v19, s[40:43], s8 offen nt lds
  s_add_u32 m0, s13, 0xe000
  s_add_u32 s8, s9, 0x2000
  buffer_load_dwordx4 v19, s[40:43], s8 offen nt lds
  s_add_u32 m0, s13, 0xf000
  s_add_u32 s8, s9, 0x3000
  buffer_load_dwordx4 v19, s[40:43], s8 offen nt lds
  s_waitcnt vmcnt(16)
  s_barrier
  s_lshl_b32 s9, s15, 14
  s_add_u32 s9, s9, 458752
  s_add_u32 s9, s9, s69
  s_add_u32 m0, s13, 0x14000
  s_add_u32 s8, s9, 0x0
  buffer_load_dwordx4 v19, s[40:43], s8 offen nt lds
  s_add_u32 m0, s13, 0x15000
  s_add_u32 s8, s9, 0x1000
  buffer_load_dwordx4 v19, s[40:43], s8 offen nt lds
  s_add_u32 m0, s13, 0x16000
  s_add_u32 s8, s9, 0x2000
  buffer_load_dwordx4 v19, s[40:43], s8 offen nt lds
  s_add_u32 m0, s13, 0x17000
  s_add_u32 s8, s9, 0x3000
  buffer_load_dwordx4 v19, s[40:43], s8 offen nt lds
  s_add_u32 s8, s66, 0x0
  buffer_load_dwordx4 v[32:35], v1, s[48:51], s8 offen
  s_add_u32 s8, s66, 0x800
  buffer_load_dwordx4 v[32:35], v1, s[48:51], s8 offen
  s_add_u32 s8, s66, 0x1000
  buffer_load_dwordx4 v[32:35], v1, s[48:51], s8 offen
  s_add_u32 s8, s66, 0x1800
  buffer_load_dwordx4 v[32:35], v1, s[48:51], s8 offen
  s_add_u32 s8, s66, 0x2000
  buffer_load_dwordx4 v[32:35], v1, s[48:51], s8 offen
  s_add_u32 s8, s66, 0x2800
  buffer_load_dwordx4 v[32:35], v1, s[48:51], s8 offen
  s_add_u32 s8, s66, 0x3000
  buffer_load_dwordx4 v[32:35], v1, s[48:51], s8 offen
  s_add_u32 s8, s66, 0x3800
  buffer_load_dwordx4 v[32:35], v1, s[48:51], s8 offen
  s_waitcnt vmcnt(20)
  s_barrier
  s_waitcnt vmcnt(12)
  s_barrier
  s_add_u32 s9, s67, 0
  s_and_b32 s9, s9, 3
  s_lshl_b32 s9, s9, 19
  s_add_u32 s9, s9, s64
  s_add_u32 m0, s13, 0x18000
  s_add_u32 s8, s9, 0x0
  buffer_load_dwordx4 v20, s[48:51], s8 offen lds
  s_add_u32 m0, s13, 0x19000
  s_add_u32 s8, s9, 0x10000
  buffer_load_dwordx4 v20, s[48:51], s8 offen lds
  s_add_u32 m0, s13, 0x1a000
  s_add_u32 s8, s9, 0x20000
  buffer_load_dwordx4 v20, s[48:51], s8 offen lds
  s_add_u32 m0, s13, 0x1b000
  s_add_u32 s8, s9, 0x30000
  buffer_load_dwordx4 v20, s[48:51], s8 offen lds
  s_add_u32 m0, s13, 0x1c000
  s_add_u32 s8, s9, 0x40000
  buffer_load_dwordx4 v20, s[48:51], s8 offen lds
  s_add_u32 m0, s13, 0x1d000
  s_add_u32 s8, s9, 0x50000
  buffer_load_dwordx4 v20, s[48:51], s8 offen lds
  s_add_u32 m0, s13, 0x1e000
  s_add_u32 s8, s9, 0x60000
  buffer_load_dwordx4 v20, s[48:51], s8 offen lds
  s_add_u32 m0, s13, 0x1f000
  s_add_u32 s8, s9, 0x70000
  buffer_load_dwordx4 v20, s[48:51], s8 offen lds
  s_add_u32 s9, s67, 1
  s_and_b32 s9, s9, 3
  s_lshl_b32 s9, s9, 19
  s_add_u32 s9, s9, s64
  s_add_u32 m0, s13, 0x20000
  s_add_u32 s8, s9, 0x0
  buffer_load_dwordx4 v20, s[48:51], s8 offen lds
  s_add_u32 m0, s13, 0x21000
  s_add_u32 s8, s9, 0x10000
  buffer_load_dwordx4 v20, s[48:51], s8 offen lds
  s_add_u32 m0, s13, 0x22000
  s_add_u32 s8, s9, 0x20000
  buffer_load_dwordx4 v20, s[48:51], s8 offen lds
  s_add_u32 m0, s13, 0x23000
  s_add_u32 s8, s9, 0x30000
  buffer_load_dwordx4 v20, s[48:51], s8 offen lds
  s_add_u32 m0, s13, 0x24000
  s_add_u32 s8, s9, 0x40000
  buffer_load_dwordx4 v20, s[48:51], s8 offen lds
  s_add_u32 m0, s13, 0x25000
  s_add_u32 s8, s9, 0x50000
  buffer_load_dwordx4 v20, s[48:51], s8 offen lds
  s_add_u32 m0, s13, 0x26000
  s_add_u32 s8, s9, 0x60000
  buffer_load_dwordx4 v20, s[48:51], s8 offen lds
  s_add_u32 m0, s13, 0x27000
  s_add_u32 s8, s9, 0x70000
  buffer_load_dwordx4 v20, s[48:51], s8 offen lds
  s_waitcnt vmcnt(24)
  s_barrier
  s_add_u32 s9, s67, 2
  s_and_b32 s9, s9, 3
  s_lshl_b32 s9, s9, 19
  s_add_u32 s9, s9, s64
  s_add_u32 m0, s13, 0x0
  s_add_u32 s8, s9, 0x0
  buffer_load_dwordx4 v20, s[48:51], s8 offen lds
  s_add_u32 m0, s13, 0x1000
  s_add_u32 s8, s9, 0x10000
  buffer_load_dwordx4 v20, s[48:51], s8 offen lds
  s_add_u32 m0, s13, 0x2000
  s_add_u32 s8, s9, 0x20000
  buffer_load_dwordx4 v20, s[48:51], s8 offen lds
  s_add_u32 m0, s13, 0x3000
  s_add_u32 s8, s9, 0x30000
  buffer_load_dwordx4 v20, s[48:51], s8 offen lds
  s_add_u32 m0, s13, 0x4000
  s_add_u32 s8, s9, 0x40000
  buffer_load_dwordx4 v20, s[48:51], s8 offen lds
  s_add_u32 m0, s13, 0x5000
  s_add_u32 s8, s9, 0x50000
  buffer_load_dwordx4 v20, s[48:51], s8 offen lds
  s_add_u32 m0, s13, 0x6000
  s_add_u32 s8, s9, 0x60000
  buffer_load_dwordx4 v20, s[48:51], s8 offen lds
  s_add_u32 m0, s13, 0x7000
  s_add_u32 s8, s9, 0x70000
  buffer_load_dwordx4 v20, s[48:51], s8 offen lds
  s_add_u32 s9, s67, 3
  s_and_b32 s9, s9, 3
  s_lshl_b32 s9, s9, 19
  s_add_u32 s9, s9, s64
  s_add_u32 m0, s13, 0x8000
  s_add_u32 s8, s9, 0x0
  buffer_load_dwordx4 v20, s[48:51], s8 offen lds
  s_add_u32 m0, s13, 0x9000
  s_add_u32 s8, s9, 0x10000
  buffer_load_dwordx4 v20, s[48:51], s8 offen lds
  s_add_u32 m0, s13, 0xa000
  s_add_u32 s8, s9, 0x20000
  buffer_load_dwordx4 v20, s[48:51], s8 offen lds
  s_add_u32 m0, s13, 0xb000
  s_add_u32 s8, s9, 0x30000
  buffer_load_dwordx4 v20, s[48:51], s8 offen lds
  s_add_u32 m0, s13, 0xc000
  s_add_u32 s8, s9, 0x40000
  buffer_load_dwordx4 v20, s[48:51], s8 offen lds
  s_add_u32 m0, s13, 0xd000
  s_add_u32 s8, s9, 0x50000
  buffer_load_dwordx4 v20, s[48:51], s8 offen lds
  s_add_u32 m0, s13, 0xe000
  s_add_u32 s8, s9, 0x60000
  buffer_load_dwordx4 v20, s[48:51], s8 offen lds
  s_add_u32 m0, s13, 0xf000
  s_add_u32 s8, s9, 0x70000
  buffer_load_dwordx4 v20, s[48:51], s8 offen lds
  s_branch L_BACK
L_CWAVE:
  s_waitcnt lgkmcnt(0)
  s_mov_b32 s60, s30
  s_and_b32 s61, s31, 0xffff
  s_mov_b32 s62, 0x10000000
  s_mov_b32 s63, 0x20000
  s_mov_b32 s56, s28
  s_and_b32 s57, s29, 0xffff
  s_mov_b32 s58, 0x100
  s_mov_b32 s59, 0x20000
  s_or_b32 s8, s2, s5
  s_cmp_lg_u32 s8, 0
  s_cbranch_scc1 L_NOPUB
  s_memrealtime s[70:71]
  s_waitcnt lgkmcnt(0)
  s_or_b32 s70, s70, 1
  s_xor_b32 s71, s71, 0x5bd1e995
  v_mov_b32 v250, s70
  v_mov_b32 v251, s71
  v_mov_b32 v255, 0
  buffer_store_dwordx2 v[250:251], v255, s[56:59], 0 offen sc1
L_NOPUB:
  s_mov_b32 s52, s26
  s_and_b32 s53, s27, 0xffff
  s_mov_b32 s54, 0x80000
  s_mov_b32 s55, 0x20000
  s_and_b32 s8, s6, 1
  s_lshl_b32 s8, s8, 13
  v_and_b32 v20, 15, v0
  v_lshrrev_b32 v21, 4, v0
  v_xor_b32 v22, v20, v21
  v_lshlrev_b32 v23, 8, v20
  v_add_u32 v23, s8, v23
  v_xor_b32 v24, 0, v22
  v_lshl_add_u32 v2, v24, 4, v23
  v_xor_b32 v24, 4, v22
  v_lshl_add_u32 v3, v24, 4, v23
  v_xor_b32 v24, 8, v22
  v_lshl_add_u32 v4, v24, 4, v23
  v_xor_b32 v24, 12, v22
  v_lshl_add_u32 v5, v24, 4, v23
  v_lshrrev_b32 v22, 2, v20
  v_lshl_add_u32 v23, v21, 3, v22
  v_lshlrev_b32 v23, 7, v23
  v_and_b32 v24, 3, v0
  s_lshr_b32 s8, s6, 1
  s_lshl_b32 s8, s8, 2
  v_add_u32 v24, s8, v24
  v_lshlrev_b32 v26, 1, v22
  v_and_b32 v26, 4, v26
  v_xor_b32 v24, v24, v26
  v_lshl_add_u32 v23, v24, 4, v23
  v_add_u32 v10, 16384, v23
  s_barrier
  ds_read_b64_tr_b16 v[16:17], v10 offset:32768
  ds_read_b64_tr_b16 v[18:19], v10 offset:33280
  ds_read_b128 v[24:27], v2 offset:32768
  ds_read_b64_tr_b16 v[20:21], v10 offset:32776
  ds_read_b64_tr_b16 v[22:23], v10 offset:33288
  ds_read_b128 v[28:31], v2 offset:36864
  ds_read_b64_tr_b16 v[32:33], v10 offset:36864
  ds_read_b64_tr_b16 v[34:35], v10 offset:37376
  ds_read_b128 v[40:43], v3 offset:32768
  ds_read_b64_tr_b16 v[36:37], v10 offset:36872
  ds_read_b64_tr_b16 v[38:39], v10 offset:37384
  ds_read_b128 v[44:47], v3 offset:36864
  s_waitcnt lgkmcnt(6)
  v_mfma_f32_16x16x32_bf16 v[112:115], v[16:19], v[24:27], 0
  ds_read_b64_tr_b16 v[48:49], v10 offset:40960
  ds_read_b64_tr_b16 v[50:51], v10 offset:41472
  ds_read_b128 v[56:59], v4 offset:32768
  ds_read_b64_tr_b16 v[52:53], v10 offset:40968
  ds_read_b64_tr_b16 v[54:55], v10 offset:41480
  ds_read_b128 v[60:63], v4 offset:36864
  v_mfma_f32_16x16x32_bf16 v[120:123], v[16:19], v[28:31], 0
  v_mfma_f32_16x16x32_bf16 v[116:119], v[20:23], v[24:27], 0
  v_mfma_f32_16x16x32_bf16 v[124:127], v[20:23], v[28:31], 0
  s_waitcnt lgkmcnt(6)
  v_mfma_f32_16x16x32_bf16 v[112:115], v[32:35], v[40:43], v[112:115]
  ds_read_b64_tr_b16 v[64:65], v10 offset:45056
  ds_read_b64_tr_b16 v[66:67], v10 offset:45568
  ds_read_b128 v[72:75], v5 offset:32768
  ds_read_b64_tr_b16 v[68:69], v10 offset:45064
  ds_read_b64_tr_b16 v[70:71], v10 offset:45576
  ds_read_b128 v[76:79], v5 offset:36864
  v_mfma_f32_16x16x32_bf16 v[120:123], v[32:35], v[44:47], v[120:123]
  v_mfma_f32_16x16x32_bf16 v[116:119], v[36:39], v[40:43], v[116:119]
  v_mfma_f32_16x16x32_bf16 v[124:127], v[36:39], v[44:47], v[124:127]
  s_waitcnt lgkmcnt(6)
  v_mfma_f32_16x16x32_bf16 v[112:115], v[48:51], v[56:59], v[112:115]
  v_mfma_f32_16x16x32_bf16 v[120:123], v[48:51], v[60:63], v[120:123]
  v_mfma_f32_16x16x32_bf16 v[116:119], v[52:55], v[56:59], v[116:119]
  v_mfma_f32_16x16x32_bf16 v[124:127], v[52:55], v[60:63], v[124:127]
  s_waitcnt lgkmcnt(0)
  v_mfma_f32_16x16x32_bf16 v[112:115], v[64:67], v[72:75], v[112:115]
  v_mfma_f32_16x16x32_bf16 v[120:123], v[64:67], v[76:79], v[120:123]
  v_mfma_f32_16x16x32_bf16 v[116:119], v[68:71], v[72:75], v[116:119]
  v_mfma_f32_16x16x32_bf16 v[124:127], v[68:71], v[76:79], v[124:127]
  s_mov_b32 s8, 0x10000
  v_add_u32 v2, s8, v2
  v_add_u32 v3, s8, v3
  v_add_u32 v4, s8, v4
  v_add_u32 v5, s8, v5
  v_add_u32 v10, s8, v10
  s_barrier
  ds_read_b64_tr_b16 v[16:17], v10 offset:0
  ds_read_b64_tr_b16 v[18:19], v10 offset:512
  ds_read_b128 v[24:27], v2 offset:0
  ds_read_b64_tr_b16 v[20:21], v10 offset:8
  ds_read_b64_tr_b16 v[22:23], v10 offset:520
  ds_read_b128 v[28:31], v2 offset:4096
  ds_read_b64_tr_b16 v[32:33], v10 offset:4096
  ds_read_b64_tr_b16 v[34:35], v10 offset:4608
  ds_read_b128 v[40:43], v3 offset:0
  ds_read_b64_tr_b16 v[36:37], v10 offset:4104
  ds_read_b64_tr_b16 v[38:39], v10 offset:4616
  ds_read_b128 v[44:47], v3 offset:4096
  s_waitcnt lgkmcnt(6)
  v_mfma_f32_16x16x32_bf16 v[112:115], v[16:19], v[24:27], v[112:115]
  ds_read_b64_tr_b16 v[48:49], v10 offset:8192
  ds_read_b64_tr_b16 v[50:51], v10 offset:8704
  ds_read_b128 v[56:59], v4 offset:0
  ds_read_b64_tr_b16 v[52:53], v10 offset:8200
  ds_read_b64_tr_b16 v[54:55], v10 offset:8712
  ds_read_b128 v[60:63], v4 offset:4096
  v_mfma_f32_16x16x32_bf16 v[120:123], v[16:19], v[28:31], v[120:123]
  v_mfma_f32_16x16x32_bf16 v[116:119], v[20:23], v[24:27], v[116:119]
  v_mfma_f32_16x16x32_bf16 v[124:127], v[20:23], v[28:31], v[124:127]
  s_waitcnt lgkmcnt(6)
  v_mfma_f32_16x16x32_bf16 v[112:115], v[32:35], v[40:43], v[112:115]
  ds_read_b64_tr_b16 v[64:65], v10 offset:12288
  ds_read_b64_tr_b16 v[66:67], v10 offset:12800
  ds_read_b128 v[72:75], v5 offset:0
  ds_read_b64_tr_b16 v[68:69], v10 offset:12296
  ds_read_b64_tr_b16 v[70:71], v10 offset:12808
  ds_read_b128 v[76:79], v5 offset:4096
  v_mfma_f32_16x16x32_bf16 v[120:123], v[32:35], v[44:47], v[120:123]
  v_mfma_f32_16x16x32_bf16 v[116:119], v[36:39], v[40:43], v[116:119]
  v_mfma_f32_16x16x32_bf16 v[124:127], v[36:39], v[44:47], v[124:127]
  s_waitcnt lgkmcnt(6)
  v_mfma_f32_16x16x32_bf16 v[112:115], v[48:51], v[56:59], v[112:115]
  v_mfma_f32_16x16x32_bf16 v[120:123], v[48:51], v[60:63], v[120:123]
  v_mfma_f32_16x16x32_bf16 v[116:119], v[52:55], v[56:59], v[116:119]
  v_mfma_f32_16x16x32_bf16 v[124:127], v[52:55], v[60:63], v[124:127]
  s_waitcnt lgkmcnt(0)
  v_mfma_f32_16x16x32_bf16 v[112:115], v[64:67], v[72:75], v[112:115]
  v_mfma_f32_16x16x32_bf16 v[120:123], v[64:67], v[76:79], v[120:123]
  v_mfma_f32_16x16x32_bf16 v[116:119], v[68:71], v[72:75], v[116:119]
  v_mfma_f32_16x16x32_bf16 v[124:127], v[68:71], v[76:79], v[124:127]
  s_barrier
  ds_read_b64_tr_b16 v[16:17], v10 offset:32768
  ds_read_b64_tr_b16 v[18:19], v10 offset:33280
  ds_read_b128 v[24:27], v2 offset:32768
  ds_read_b64_tr_b16 v[20:21], v10 offset:32776
  ds_read_b64_tr_b16 v[22:23], v10 offset:33288
  ds_read_b128 v[28:31], v2 offset:36864
  ds_read_b64_tr_b16 v[32:33], v10 offset:36864
  ds_read_b64_tr_b16 v[34:35], v10 offset:37376
  ds_read_b128 v[40:43], v3 offset:32768
  ds_read_b64_tr_b16 v[36:37], v10 offset:36872
  ds_read_b64_tr_b16 v[38:39], v10 offset:37384
  ds_read_b128 v[44:47], v3 offset:36864
  s_waitcnt lgkmcnt(6)
  v_mfma_f32_16x16x32_bf16 v[112:115], v[16:19], v[24:27], v[112:115]
  ds_read_b64_tr_b16 v[48:49], v10 offset:40960
  ds_read_b64_tr_b16 v[50:51], v10 offset:41472
  ds_read_b128 v[56:59], v4 offset:32768
  ds_read_b64_tr_b16 v[52:53], v10 offset:40968
  ds_read_b64_tr_b16 v[54:55], v10 offset:41480
  ds_read_b128 v[60:63], v4 offset:36864
  v_mfma_f32_16x16x32_bf16 v[120:123], v[16:19], v[28:31], v[120:123]
  v_mfma_f32_16x16x32_bf16 v[116:119], v[20:23], v[24:27], v[116:119]
  v_mfma_f32_16x16x32_bf16 v[124:127], v[20:23], v[28:31], v[124:127]
  s_waitcnt lgkmcnt(6)
  v_mfma_f32_16x16x32_bf16 v[112:115], v[32:35], v[40:43], v[112:115]
  ds_read_b64_tr_b16 v[64:65], v10 offset:45056
  ds_read_b64_tr_b16 v[66:67], v10 offset:45568
  ds_read_b128 v[72:75], v5 offset:32768
  ds_read_b64_tr_b16 v[68:69], v10 offset:45064
  ds_read_b64_tr_b16 v[70:71], v10 offset:45576
  ds_read_b128 v[76:79], v5 offset:36864
  v_mfma_f32_16x16x32_bf16 v[120:123], v[32:35], v[44:47], v[120:123]
  v_mfma_f32_16x16x32_bf16 v[116:119], v[36:39], v[40:43], v[116:119]
  v_mfma_f32_16x16x32_bf16 v[124:127], v[36:39], v[44:47], v[124:127]
  s_waitcnt lgkmcnt(6)
  v_mfma_f32_16x16x32_bf16 v[112:115], v[48:51], v[56:59], v[112:115]
  v_mfma_f32_16x16x32_bf16 v[120:123], v[48:51], v[60:63], v[120:123]
  v_mfma_f32_16x16x32_bf16 v[116:119], v[52:55], v[56:59], v[116:119]
  v_mfma_f32_16x16x32_bf16 v[124:127], v[52:55], v[60:63], v[124:127]
  s_waitcnt lgkmcnt(0)
  v_mfma_f32_16x16x32_bf16 v[112:115], v[64:67], v[72:75], v[112:115]
  v_mfma_f32_16x16x32_bf16 v[120:123], v[64:67], v[76:79], v[120:123]
  v_mfma_f32_16x16x32_bf16 v[116:119], v[68:71], v[72:75], v[116:119]
  v_mfma_f32_16x16x32_bf16 v[124:127], v[68:71], v[76:79], v[124:127]
  s_mov_b32 s8, 0x10000
  v_add_u32 v2, s8, v2
  v_add_u32 v3, s8, v3
  v_add_u32 v4, s8, v4
  v_add_u32 v5, s8, v5
  v_add_u32 v10, s8, v10
  s_barrier
  ds_read_b64_tr_b16 v[16:17], v10 offset:0
  ds_read_b64_tr_b16 v[18:19], v10 offset:512
  ds_read_b128 v[24:27], v2 offset:0
  ds_read_b64_tr_b16 v[20:21], v10 offset:8
  ds_read_b64_tr_b16 v[22:23], v10 offset:520
  ds_read_b128 v[28:31], v2 offset:4096
  ds_read_b64_tr_b16 v[32:33], v10 offset:4096
  ds_read_b64_tr_b16 v[34:35], v10 offset:4608
  ds_read_b128 v[40:43], v3 offset:0
  ds_read_b64_tr_b16 v[36:37], v10 offset:4104
  ds_read_b64_tr_b16 v[38:39], v10 offset:4616
  ds_read_b128 v[44:47], v3 offset:4096
  s_waitcnt lgkmcnt(6)
  v_mfma_f32_16x16x32_bf16 v[112:115], v[16:19], v[24:27], v[112:115]
  ds_read_b64_tr_b16 v[48:49], v10 offset:8192
  ds_read_b64_tr_b16 v[50:51], v10 offset:8704
  ds_read_b128 v[56:59], v4 offset:0
  ds_read_b64_tr_b16 v[52:53], v10 offset:8200
  ds_read_b64_tr_b16 v[54:55], v10 offset:8712
  ds_read_b128 v[60:63], v4 offset:4096
  v_mfma_f32_16x16x32_bf16 v[120:123], v[16:19], v[28:31], v[120:123]
  v_mfma_f32_16x16x32_bf16 v[116:119], v[20:23], v[24:27], v[116:119]
  v_mfma_f32_16x16x32_bf16 v[124:127], v[20:23], v[28:31], v[124:127]
  s_waitcnt lgkmcnt(6)
  v_mfma_f32_16x16x32_bf16 v[112:115], v[32:35], v[40:43], v[112:115]
  ds_read_b64_tr_b16 v[64:65], v10 offset:12288
  ds_read_b64_tr_b16 v[66:67], v10 offset:12800
  ds_read_b128 v[72:75], v5 offset:0
  ds_read_b64_tr_b16 v[68:69], v10 offset:12296
  ds_read_b64_tr_b16 v[70:71], v10 offset:12808
  ds_read_b128 v[76:79], v5 offset:4096
  v_mfma_f32_16x16x32_bf16 v[120:123], v[32:35], v[44:47], v[120:123]
  v_mfma_f32_16x16x32_bf16 v[116:119], v[36:39], v[40:43], v[116:119]
  v_mfma_f32_16x16x32_bf16 v[124:127], v[36:39], v[44:47], v[124:127]
  s_waitcnt lgkmcnt(6)
  v_mfma_f32_16x16x32_bf16 v[112:115], v[48:51], v[56:59], v[112:115]
  v_mfma_f32_16x16x32_bf16 v[120:123], v[48:51], v[60:63], v[120:123]
  v_mfma_f32_16x16x32_bf16 v[116:119], v[52:55], v[56:59], v[116:119]
  v_mfma_f32_16x16x32_bf16 v[124:127], v[52:55], v[60:63], v[124:127]
  s_waitcnt lgkmcnt(0)
  v_mfma_f32_16x16x32_bf16 v[112:115], v[64:67], v[72:75], v[112:115]
  v_mfma_f32_16x16x32_bf16 v[120:123], v[64:67], v[76:79], v[120:123]
  v_mfma_f32_16x16x32_bf16 v[116:119], v[68:71], v[72:75], v[116:119]
  v_mfma_f32_16x16x32_bf16 v[124:127], v[68:71], v[76:79], v[124:127]
  s_mov_b32 s8, 0xfffe0000
  v_add_u32 v2, s8, v2
  v_add_u32 v3, s8, v3
  v_add_u32 v4, s8, v4
  v_add_u32 v5, s8, v5
  v_add_u32 v10, s8, v10
  s_barrier
  ds_read_b64_tr_b16 v[16:17], v10 offset:32768
  ds_read_b64_tr_b16 v[18:19], v10 offset:33280
  ds_read_b128 v[24:27], v2 offset:32768
  ds_read_b64_tr_b16 v[20:21], v10 offset:32776
  ds_read_b64_tr_b16 v[22:23], v10 offset:33288
  ds_read_b128 v[28:31], v2 offset:36864
  ds_read_b64_tr_b16 v[32:33], v10 offset:36864
  ds_read_b64_tr_b16 v[34:35], v10 offset:37376
  ds_read_b128 v[40:43], v3 offset:32768
  ds_read_b64_tr_b16 v[36:37], v10 offset:36872
  ds_read_b64_tr_b16 v[38:39], v10 offset:37384
  ds_read_b128 v[44:47], v3 offset:36864
  s_waitcnt lgkmcnt(6)
  v_mfma_f32_16x16x32_bf16 v[112:115], v[16:19], v[24:27], v[112:115]
  ds_read_b64_tr_b16 v[48:49], v10 offset:40960
  ds_read_b64_tr_b16 v[50:51], v10 offset:41472
  ds_read_b128 v[56:59], v4 offset:32768
  ds_read_b64_tr_b16 v[52:53], v10 offset:40968
  ds_read_b64_tr_b16 v[54:55], v10 offset:41480
  ds_read_b128 v[60:63], v4 offset:36864
  v_mfma_f32_16x16x32_bf16 v[120:123], v[16:19], v[28:31], v[120:123]
  v_mfma_f32_16x16x32_bf16 v[116:119], v[20:23], v[24:27], v[116:119]
  v_mfma_f32_16x16x32_bf16 v[124:127], v[20:23], v[28:31], v[124:127]
  s_waitcnt lgkmcnt(6)
  v_mfma_f32_16x16x32_bf16 v[112:115], v[32:35], v[40:43], v[112:115]
  ds_read_b64_tr_b16 v[64:65], v10 offset:45056
  ds_read_b64_tr_b16 v[66:67], v10 offset:45568
  ds_read_b128 v[72:75], v5 offset:32768
  ds_read_b64_tr_b16 v[68:69], v10 offset:45064
  ds_read_b64_tr_b16 v[70:71], v10 offset:45576
  ds_read_b128 v[76:79], v5 offset:36864
  v_mfma_f32_16x16x32_bf16 v[120:123], v[32:35], v[44:47], v[120:123]
  v_mfma_f32_16x16x32_bf16 v[116:119], v[36:39], v[40:43], v[116:119]
  v_mfma_f32_16x16x32_bf16 v[124:127], v[36:39], v[44:47], v[124:127]
  s_waitcnt lgkmcnt(6)
  v_mfma_f32_16x16x32_bf16 v[112:115], v[48:51], v[56:59], v[112:115]
  v_mfma_f32_16x16x32_bf16 v[120:123], v[48:51], v[60:63], v[120:123]
  v_mfma_f32_16x16x32_bf16 v[116:119], v[52:55], v[56:59], v[116:119]
  v_mfma_f32_16x16x32_bf16 v[124:127], v[52:55], v[60:63], v[124:127]
  s_waitcnt lgkmcnt(0)
  v_mfma_f32_16x16x32_bf16 v[112:115], v[64:67], v[72:75], v[112:115]
  v_mfma_f32_16x16x32_bf16 v[120:123], v[64:67], v[76:79], v[120:123]
  v_mfma_f32_16x16x32_bf16 v[116:119], v[68:71], v[72:75], v[116:119]
  v_mfma_f32_16x16x32_bf16 v[124:127], v[68:71], v[76:79], v[124:127]
  s_mov_b32 s8, 0x10000
  v_add_u32 v2, s8, v2
  v_add_u32 v3, s8, v3
  v_add_u32 v4, s8, v4
  v_add_u32 v5, s8, v5
  v_add_u32 v10, s8, v10
  s_barrier
  ds_read_b64_tr_b16 v[16:17], v10 offset:0
  ds_read_b64_tr_b16 v[18:19], v10 offset:512
  ds_read_b128 v[24:27], v2 offset:0
  ds_read_b64_tr_b16 v[20:21], v10 offset:8
  ds_read_b64_tr_b16 v[22:23], v10 offset:520
  ds_read_b128 v[28:31], v2 offset:4096
  ds_read_b64_tr_b16 v[32:33], v10 offset:4096
  ds_read_b64_tr_b16 v[34:35], v10 offset:4608
  ds_read_b128 v[40:43], v3 offset:0
  ds_read_b64_tr_b16 v[36:37], v10 offset:4104
  ds_read_b64_tr_b16 v[38:39], v10 offset:4616
  ds_read_b128 v[44:47], v3 offset:4096
  s_waitcnt lgkmcnt(6)
  v_mfma_f32_16x16x32_bf16 v[112:115], v[16:19], v[24:27], v[112:115]
  ds_read_b64_tr_b16 v[48:49], v10 offset:8192
  ds_read_b64_tr_b16 v[50:51], v10 offset:8704
  ds_read_b128 v[56:59], v4 offset:0
  ds_read_b64_tr_b16 v[52:53], v10 offset:8200
  ds_read_b64_tr_b16 v[54:55], v10 offset:8712
  ds_read_b128 v[60:63], v4 offset:4096
  v_mfma_f32_16x16x32_bf16 v[120:123], v[16:19], v[28:31], v[120:123]
  v_mfma_f32_16x16x32_bf16 v[116:119], v[20:23], v[24:27], v[116:119]
  v_mfma_f32_16x16x32_bf16 v[124:127], v[20:23], v[28:31], v[124:127]
  s_waitcnt lgkmcnt(6)
  v_mfma_f32_16x16x32_bf16 v[112:115], v[32:35], v[40:43], v[112:115]
  ds_read_b64_tr_b16 v[64:65], v10 offset:12288
  ds_read_b64_tr_b16 v[66:67], v10 offset:12800
  ds_read_b128 v[72:75], v5 offset:0
  ds_read_b64_tr_b16 v[68:69], v10 offset:12296
  ds_read_b64_tr_b16 v[70:71], v10 offset:12808
  ds_read_b128 v[76:79], v5 offset:4096
  v_mfma_f32_16x16x32_bf16 v[120:123], v[32:35], v[44:47], v[120:123]
  v_mfma_f32_16x16x32_bf16 v[116:119], v[36:39], v[40:43], v[116:119]
  v_mfma_f32_16x16x32_bf16 v[124:127], v[36:39], v[44:47], v[124:127]
  s_waitcnt lgkmcnt(6)
  v_mfma_f32_16x16x32_bf16 v[112:115], v[48:51], v[56:59], v[112:115]
  v_mfma_f32_16x16x32_bf16 v[120:123], v[48:51], v[60:63], v[120:123]
  v_mfma_f32_16x16x32_bf16 v[116:119], v[52:55], v[56:59], v[116:119]
  v_mfma_f32_16x16x32_bf16 v[124:127], v[52:55], v[60:63], v[124:127]
  s_waitcnt lgkmcnt(0)
  v_mfma_f32_16x16x32_bf16 v[112:115], v[64:67], v[72:75], v[112:115]
  v_mfma_f32_16x16x32_bf16 v[120:123], v[64:67], v[76:79], v[120:123]
  v_mfma_f32_16x16x32_bf16 v[116:119], v[68:71], v[72:75], v[116:119]
  v_mfma_f32_16x16x32_bf16 v[124:127], v[68:71], v[76:79], v[124:127]
  s_barrier
  ds_read_b64_tr_b16 v[16:17], v10 offset:32768
  ds_read_b64_tr_b16 v[18:19], v10 offset:33280
  ds_read_b128 v[24:27], v2 offset:32768
  ds_read_b64_tr_b16 v[20:21], v10 offset:32776
  ds_read_b64_tr_b16 v[22:23], v10 offset:33288
  ds_read_b128 v[28:31], v2 offset:36864
  ds_read_b64_tr_b16 v[32:33], v10 offset:36864
  ds_read_b64_tr_b16 v[34:35], v10 offset:37376
  ds_read_b128 v[40:43], v3 offset:32768
  ds_read_b64_tr_b16 v[36:37], v10 offset:36872
  ds_read_b64_tr_b16 v[38:39], v10 offset:37384
  ds_read_b128 v[44:47], v3 offset:36864
  s_waitcnt lgkmcnt(6)
  v_mfma_f32_16x16x32_bf16 v[112:115], v[16:19], v[24:27], v[112:115]
  ds_read_b64_tr_b16 v[48:49], v10 offset:40960
  ds_read_b64_tr_b16 v[50:51], v10 offset:41472
  ds_read_b128 v[56:59], v4 offset:32768
  ds_read_b64_tr_b16 v[52:53], v10 offset:40968
  ds_read_b64_tr_b16 v[54:55], v10 offset:41480
  ds_read_b128 v[60:63], v4 offset:36864
  v_mfma_f32_16x16x32_bf16 v[120:123], v[16:19], v[28:31], v[120:123]
  v_mfma_f32_16x16x32_bf16 v[116:119], v[20:23], v[24:27], v[116:119]
  v_mfma_f32_16x16x32_bf16 v[124:127], v[20:23], v[28:31], v[124:127]
  s_waitcnt lgkmcnt(6)
  v_mfma_f32_16x16x32_bf16 v[112:115], v[32:35], v[40:43], v[112:115]
  ds_read_b64_tr_b16 v[64:65], v10 offset:45056
  ds_read_b64_tr_b16 v[66:67], v10 offset:45568
  ds_read_b128 v[72:75], v5 offset:32768
  ds_read_b64_tr_b16 v[68:69], v10 offset:45064
  ds_read_b64_tr_b16 v[70:71], v10 offset:45576
  ds_read_b128 v[76:79], v5 offset:36864
  v_mfma_f32_16x16x32_bf16 v[120:123], v[32:35], v[44:47], v[120:123]
  v_mfma_f32_16x16x32_bf16 v[116:119], v[36:39], v[40:43], v[116:119]
  v_mfma_f32_16x16x32_bf16 v[124:127], v[36:39], v[44:47], v[124:127]
  s_waitcnt lgkmcnt(6)
  v_mfma_f32_16x16x32_bf16 v[112:115], v[48:51], v[56:59], v[112:115]
  v_mfma_f32_16x16x32_bf16 v[120:123], v[48:51], v[60:63], v[120:123]
  v_mfma_f32_16x16x32_bf16 v[116:119], v[52:55], v[56:59], v[116:119]
  v_mfma_f32_16x16x32_bf16 v[124:127], v[52:55], v[60:63], v[124:127]
  s_waitcnt lgkmcnt(0)
  v_mfma_f32_16x16x32_bf16 v[112:115], v[64:67], v[72:75], v[112:115]
  v_mfma_f32_16x16x32_bf16 v[120:123], v[64:67], v[76:79], v[120:123]
  v_mfma_f32_16x16x32_bf16 v[116:119], v[68:71], v[72:75], v[116:119]
  v_mfma_f32_16x16x32_bf16 v[124:127], v[68:71], v[76:79], v[124:127]
  s_mov_b32 s8, 0x10000
  v_add_u32 v2, s8, v2
  v_add_u32 v3, s8, v3
  v_add_u32 v4, s8, v4
  v_add_u32 v5, s8, v5
  v_add_u32 v10, s8, v10
  s_barrier
  ds_read_b64_tr_b16 v[16:17], v10 offset:0
  ds_read_b64_tr_b16 v[18:19], v10 offset:512
  ds_read_b128 v[24:27], v2 offset:0
  ds_read_b64_tr_b16 v[20:21], v10 offset:8
  ds_read_b64_tr_b16 v[22:23], v10 offset:520
  ds_read_b128 v[28:31], v2 offset:4096
  ds_read_b64_tr_b16 v[32:33], v10 offset:4096
  ds_read_b64_tr_b16 v[34:35], v10 offset:4608
  ds_read_b128 v[40:43], v3 offset:0
  ds_read_b64_tr_b16 v[36:37], v10 offset:4104
  ds_read_b64_tr_b16 v[38:39], v10 offset:4616
  ds_read_b128 v[44:47], v3 offset:4096
  s_waitcnt lgkmcnt(6)
  v_mfma_f32_16x16x32_bf16 v[112:115], v[16:19], v[24:27], v[112:115]
  ds_read_b64_tr_b16 v[48:49], v10 offset:8192
  ds_read_b64_tr_b16 v[50:51], v10 offset:8704
  ds_read_b128 v[56:59], v4 offset:0
  ds_read_b64_tr_b16 v[52:53], v10 offset:8200
  ds_read_b64_tr_b16 v[54:55], v10 offset:8712
  ds_read_b128 v[60:63], v4 offset:4096
  v_mfma_f32_16x16x32_bf16 v[120:123], v[16:19], v[28:31], v[120:123]
  v_mfma_f32_16x16x32_bf16 v[116:119], v[20:23], v[24:27], v[116:119]
  v_mfma_f32_16x16x32_bf16 v[124:127], v[20:23], v[28:31], v[124:127]
  s_waitcnt lgkmcnt(6)
  v_mfma_f32_16x16x32_bf16 v[112:115], v[32:35], v[40:43], v[112:115]
  ds_read_b64_tr_b16 v[64:65], v10 offset:12288
  ds_read_b64_tr_b16 v[66:67], v10 offset:12800
  ds_read_b128 v[72:75], v5 offset:0
  ds_read_b64_tr_b16 v[68:69], v10 offset:12296
  ds_read_b64_tr_b16 v[70:71], v10 offset:12808
  ds_read_b128 v[76:79], v5 offset:4096
  v_mfma_f32_16x16x32_bf16 v[120:123], v[32:35], v[44:47], v[120:123]
  v_mfma_f32_16x16x32_bf16 v[116:119], v[36:39], v[40:43], v[116:119]
  v_mfma_f32_16x16x32_bf16 v[124:127], v[36:39], v[44:47], v[124:127]
  s_waitcnt lgkmcnt(6)
  v_mfma_f32_16x16x32_bf16 v[112:115], v[48:51], v[56:59], v[112:115]
  v_mfma_f32_16x16x32_bf16 v[120:123], v[48:51], v[60:63], v[120:123]
  v_mfma_f32_16x16x32_bf16 v[116:119], v[52:55], v[56:59], v[116:119]
  v_mfma_f32_16x16x32_bf16 v[124:127], v[52:55], v[60:63], v[124:127]
  s_waitcnt lgkmcnt(0)
  v_mfma_f32_16x16x32_bf16 v[112:115], v[64:67], v[72:75], v[112:115]
  v_mfma_f32_16x16x32_bf16 v[120:123], v[64:67], v[76:79], v[120:123]
  v_mfma_f32_16x16x32_bf16 v[116:119], v[68:71], v[72:75], v[116:119]
  v_mfma_f32_16x16x32_bf16 v[124:127], v[68:71], v[76:79], v[124:127]
  s_load_dwordx2 s[70:71], s[28:29], 0
  s_and_b32 s8, s6, 1
  s_lshl_b32 s9, s67, 1
  s_add_u32 s9, s9, s8
  s_lshl_b32 s9, s9, 5
  s_lshr_b32 s10, s66, 1
  s_add_u32 s9, s9, s10
  s_and_b32 s10, s66, 1
  s_lshl_b32 s10, s10, 1
  s_lshr_b32 s11, s6, 1
  s_add_u32 s10, s10, s11
  s_lshl_b32 s64, s9, 13
  s_lshl_b32 s11, s10, 10
  s_add_u32 s64, s64, s11
  s_add_u32 s69, s64, 4096
  s_mul_i32 s65, s9, 1152
  s_lshl_b32 s11, s10, 3
  s_add_u32 s65, s65, s11
  s_add_u32 s65, s65, 0x2000000
  s_mov_b32 s8, 0x3e0293ee
  v_mul_f32 v112, s8, v112
  v_mul_f32 v113, s8, v113
  v_mul_f32 v114, s8, v114
  v_mul_f32 v115, s8, v115
  v_mul_f32 v116, s8, v116
  v_mul_f32 v117, s8, v117
  v_mul_f32 v118, s8, v118
  v_mul_f32 v119, s8, v119
  v_mul_f32 v120, s8, v120
  v_mul_f32 v121, s8, v121
  v_mul_f32 v122, s8, v122
  v_mul_f32 v123, s8, v123
  v_mul_f32 v124, s8, v124
  v_mul_f32 v125, s8, v125
  v_mul_f32 v126, s8, v126
  v_mul_f32 v127, s8, v127
  v_cvt_pk_bf16_f32 v16, v112, v113
  v_cvt_pk_bf16_f32 v17, v114, v115
  v_cvt_pk_bf16_f32 v18, v116, v117
  v_cvt_pk_bf16_f32 v19, v118, v119
  v_cvt_pk_bf16_f32 v20, v120, v121
  v_cvt_pk_bf16_f32 v21, v122, v123
  v_cvt_pk_bf16_f32 v22, v124, v125
  v_cvt_pk_bf16_f32 v23, v126, v127
  buffer_store_dwordx4 v[16:19], v1, s[60:63], s64 offen sc1
  buffer_store_dwordx4 v[20:23], v1, s[60:63], s69 offen sc1
  v_and_b32 v32, 15, v0
  v_lshrrev_b32 v33, 4, v0
  v_xor_b32 v34, v32, v33
  v_lshlrev_b32 v35, 8, v32
  v_xor_b32 v36, 0, v34
  v_lshl_add_u32 v2, v36, 4, v35
  v_xor_b32 v36, 4, v34
  v_lshl_add_u32 v3, v36, 4, v35
  v_xor_b32 v36, 8, v34
  v_lshl_add_u32 v4, v36, 4, v35
  v_xor_b32 v36, 12, v34
  v_lshl_add_u32 v5, v36, 4, v35
  v_lshrrev_b32 v36, 2, v32
  v_lshl_add_u32 v36, v33, 2, v36
  v_and_b32 v37, 7, v36
  v_lshlrev_b32 v37, 1, v37
  v_bfe_u32 v38, v0, 1, 1
  v_xor_b32 v37, v37, v38
  v_lshlrev_b32 v36, 8, v36
  v_and_b32 v38, 1, v0
  v_lshl_add_u32 v36, v38, 3, v36
  v_add_u32 v36, 16384, v36
  v_xor_b32 v38, 0, v37
  v_lshl_add_u32 v6, v38, 4, v36
  v_xor_b32 v38, 2, v37
  v_lshl_add_u32 v7, v38, 4, v36
  v_xor_b32 v38, 4, v37
  v_lshl_add_u32 v8, v38, 4, v36
  v_xor_b32 v38, 6, v37
  v_lshl_add_u32 v9, v38, 4, v36
  v_xor_b32 v38, 8, v37
  v_lshl_add_u32 v10, v38, 4, v36
  v_xor_b32 v38, 10, v37
  v_lshl_add_u32 v11, v38, 4, v36
  v_xor_b32 v38, 12, v37
  v_lshl_add_u32 v12, v38, 4, v36
  v_xor_b32 v38, 14, v37
  v_lshl_add_u32 v13, v38, 4, v36
  v_mov_b32 v240, 0x3f803f80
  v_mov_b32 v241, 0x3f803f80
  v_mov_b32 v242, 0x3f803f80
  v_mov_b32 v243, 0x3f803f80
  s_lshl_b32 s10, s75, 2
  s_add_u32 s10, s10, s6
  s_lshl_b32 s64, s10, 13
  s_mul_i32 s10, s10, 1152
  s_add_u32 s10, s10, 0x2000000
  s_mov_b32 s12, 0
NON_3:
  s_waitcnt lgkmcnt(0)
  s_cmp_lg_u32 s70, 0
  s_cbranch_scc1 NOND_4
  s_add_u32 s12, s12, 1
  s_cmp_ge_u32 s12, 0x200000
  s_cbranch_scc1 NOND_4
  s_sleep 8
  s_load_dwordx2 s[70:71], s[28:29], 0 glc
  s_branch NON_3
NOND_4:
  v_mov_b32 v250, s70
  v_mov_b32 v251, s71
  s_waitcnt vmcnt(0)
  v_mov_b32 v255, s65
  s_mov_b64 exec, 1
  buffer_store_dwordx2 v[250:251], v255, s[60:63], 0 offen sc1
  s_mov_b64 exec, -1
  s_barrier
  s_add_u32 s72, s60, s10
  s_addc_u32 s73, s61, 0
  s_mov_b32 s12, 0
POLL_5:
  s_load_dwordx8 s[16:23], s[72:73], 0 glc
  s_add_u32 s12, s12, 1
  s_cmp_ge_u32 s12, 0x200000
  s_waitcnt lgkmcnt(0)
  s_cbranch_scc1 POLLD_6
  s_cmp_eq_u64 s[16:17], s[70:71]
  s_cbranch_scc0 POLL_5
  s_cmp_eq_u64 s[18:19], s[70:71]
  s_cbranch_scc0 POLL_5
  s_cmp_eq_u64 s[20:21], s[70:71]
  s_cbranch_scc0 POLL_5
  s_cmp_eq_u64 s[22:23], s[70:71]
  s_cbranch_scc0 POLL_5
POLLD_6:
  buffer_load_dwordx4 v[80:83], v1, s[60:63], s64 offen offset:0 sc1
  buffer_load_dwordx4 v[84:87], v1, s[60:63], s64 offen offset:1024 sc1
  buffer_load_dwordx4 v[88:91], v1, s[60:63], s64 offen offset:2048 sc1
  buffer_load_dwordx4 v[92:95], v1, s[60:63], s64 offen offset:3072 sc1
  s_add_u32 s64, s64, 4096
  buffer_load_dwordx4 v[96:99], v1, s[60:63], s64 offen offset:0 sc1
  buffer_load_dwordx4 v[100:103], v1, s[60:63], s64 offen offset:1024 sc1
  buffer_load_dwordx4 v[104:107], v1, s[60:63], s64 offen offset:2048 sc1
  buffer_load_dwordx4 v[108:111], v1, s[60:63], s64 offen offset:3072 sc1
  s_barrier
  s_setprio 1
  s_barrier
  ds_read_b128 v[48:51], v2 offset:0
  ds_read_b128 v[52:55], v3 offset:0
  ds_read_b128 v[56:59], v4 offset:0
  ds_read_b128 v[60:63], v5 offset:0
  ds_read_b128 v[64:67], v2 offset:4096
  ds_read_b128 v[68:71], v3 offset:4096
  ds_read_b128 v[72:75], v4 offset:4096
  ds_read_b128 v[76:79], v5 offset:4096
  ds_read_b128 v[16:19], v2 offset:8192
  ds_read_b128 v[20:23], v3 offset:8192
  ds_read_b128 v[24:27], v4 offset:8192
  ds_read_b128 v[28:31], v5 offset:8192
  ds_read_b128 v[32:35], v2 offset:12288
  ds_read_b128 v[36:39], v3 offset:12288
  ds_read_b128 v[40:43], v4 offset:12288
  s_waitcnt vmcnt(0)
  s_waitcnt lgkmcnt(7)
  v_mfma_f32_16x16x32_bf16 v[176:179], v[48:51], v[80:83], 0
  ds_read_b128 v[44:47], v5 offset:12288
  v_mfma_f32_16x16x32_bf16 v[184:187], v[48:51], v[96:99], 0
  v_mfma_f32_16x16x32_bf16 v[176:179], v[52:55], v[84:87], v[176:179]
  v_mfma_f32_16x16x32_bf16 v[184:187], v[52:55], v[100:103], v[184:187]
  v_mfma_f32_16x16x32_bf16 v[176:179], v[56:59], v[88:91], v[176:179]
  v_mfma_f32_16x16x32_bf16 v[184:187], v[56:59], v[104:107], v[184:187]
  v_mfma_f32_16x16x32_bf16 v[176:179], v[60:63], v[92:95], v[176:179]
  v_mfma_f32_16x16x32_bf16 v[184:187], v[60:63], v[108:111], v[184:187]
  v_mfma_f32_16x16x32_bf16 v[180:183], v[64:67], v[80:83], 0
  v_mfma_f32_16x16x32_bf16 v[188:191], v[64:67], v[96:99], 0
  v_mfma_f32_16x16x32_bf16 v[180:183], v[68:71], v[84:87], v[180:183]
  v_mfma_f32_16x16x32_bf16 v[188:191], v[68:71], v[100:103], v[188:191]
  v_mfma_f32_16x16x32_bf16 v[180:183], v[72:75], v[88:91], v[180:183]
  v_mfma_f32_16x16x32_bf16 v[188:191], v[72:75], v[104:107], v[188:191]
  v_mfma_f32_16x16x32_bf16 v[180:183], v[76:79], v[92:95], v[180:183]
  v_mfma_f32_16x16x32_bf16 v[188:191], v[76:79], v[108:111], v[188:191]
  s_mov_b32 s8, 0x41100000
  s_waitcnt lgkmcnt(4)
  v_mfma_f32_16x16x32_bf16 v[192:195], v[16:19], v[80:83], 0
  v_mfma_f32_16x16x32_bf16 v[200:203], v[16:19], v[96:99], 0
  v_mfma_f32_16x16x32_bf16 v[192:195], v[20:23], v[84:87], v[192:195]
  s_nop 3
  v_mfma_f32_16x16x32_bf16 v[200:203], v[20:23], v[100:103], v[200:203]
  v_max3_f32 v248, v176, v177, v178
  v_max3_f32 v249, v179, v180, v181
  v_mfma_f32_16x16x32_bf16 v[192:195], v[24:27], v[88:91], v[192:195]
  v_max3_f32 v244, v184, v185, v186
  v_max3_f32 v245, v187, v188, v189
  v_mfma_f32_16x16x32_bf16 v[200:203], v[24:27], v[104:107], v[200:203]
  v_max3_f32 v248, v182, v183, v248
  v_max_f32 v248, v248, v249
  v_mov_b32 v249, v248
  v_mfma_f32_16x16x32_bf16 v[192:195], v[28:31], v[92:95], v[192:195]
  v_max3_f32 v244, v190, v191, v244
  v_max_f32 v244, v244, v245
  v_mov_b32 v245, v244
  v_mfma_f32_16x16x32_bf16 v[200:203], v[28:31], v[108:111], v[200:203]
  s_nop 1
  v_permlane16_swap_b32 v248, v249
  s_nop 1
  v_max_f32 v248, v248, v249
  v_mov_b32 v249, v248
  s_waitcnt lgkmcnt(0)
  v_mfma_f32_16x16x32_bf16 v[196:199], v[32:35], v[80:83], 0
  s_nop 1
  v_permlane16_swap_b32 v244, v245
  s_nop 1
  v_max_f32 v244, v244, v245
  v_mov_b32 v245, v244
  v_mfma_f32_16x16x32_bf16 v[204:207], v[32:35], v[96:99], 0
  s_nop 1
  v_permlane32_swap_b32 v248, v249
  s_nop 1
  v_max_f32 v248, v248, v249
  v_mfma_f32_16x16x32_bf16 v[196:199], v[36:39], v[84:87], v[196:199]
  s_nop 1
  v_permlane32_swap_b32 v244, v245
  s_nop 1
  v_max_f32 v244, v244, v245
  v_mfma_f32_16x16x32_bf16 v[204:207], v[36:39], v[100:103], v[204:207]
  v_add_f32 v248, s8, v248
  v_add_f32 v244, s8, v244
  v_mfma_f32_16x16x32_bf16 v[196:199], v[40:43], v[88:91], v[196:199]
  v_sub_f32 v224, 0, v248
  v_sub_f32 v225, 0, v248
  v_sub_f32 v226, 0, v248
  v_sub_f32 v227, 0, v248
  v_mfma_f32_16x16x32_bf16 v[204:207], v[40:43], v[104:107], v[204:207]
  v_sub_f32 v228, 0, v244
  v_sub_f32 v229, 0, v244
  v_sub_f32 v230, 0, v244
  v_sub_f32 v231, 0, v244
  v_mfma_f32_16x16x32_bf16 v[196:199], v[44:47], v[92:95], v[196:199]
  v_add_f32 v176, v176, v224
  v_exp_f32 v14, v176
  v_add_f32 v177, v177, v224
  v_exp_f32 v15, v177
  v_mfma_f32_16x16x32_bf16 v[204:207], v[44:47], v[108:111], v[204:207]
  v_cvt_pk_bf16_f32 v208, v14, v15
  v_add_f32 v178, v178, v224
  v_exp_f32 v248, v178
  v_add_f32 v179, v179, v224
  v_exp_f32 v249, v179
  s_barrier
  v_cvt_pk_bf16_f32 v209, v248, v249
  v_add_f32 v180, v180, v224
  v_exp_f32 v244, v180
  ds_read_b128 v[16:19], v2 offset:32768
  v_add_f32 v181, v181, v224
  v_exp_f32 v245, v181
  s_nop 0
  v_cvt_pk_bf16_f32 v210, v244, v245
  v_add_f32 v182, v182, v224
  v_exp_f32 v14, v182
  ds_read_b128 v[20:23], v3 offset:32768
  v_add_f32 v183, v183, v224
  v_exp_f32 v15, v183
  s_nop 0
  v_cvt_pk_bf16_f32 v211, v14, v15
  v_add_f32 v184, v184, v228
  v_exp_f32 v248, v184
  ds_read_b128 v[24:27], v4 offset:32768
  v_add_f32 v185, v185, v228
  v_exp_f32 v249, v185
  s_nop 0
  v_cvt_pk_bf16_f32 v212, v248, v249
  v_add_f32 v186, v186, v228
  v_exp_f32 v244, v186
  ds_read_b128 v[28:31], v5 offset:32768
  v_add_f32 v187, v187, v228
  v_exp_f32 v245, v187
  s_nop 0
  v_cvt_pk_bf16_f32 v213, v244, v245
  v_add_f32 v188, v188, v228
  v_exp_f32 v14, v188
  ds_read_b128 v[32:35], v2 offset:36864
  v_add_f32 v189, v189, v228
  v_exp_f32 v15, v189
  s_nop 0
  v_cvt_pk_bf16_f32 v214, v14, v15
  v_add_f32 v190, v190, v228
  v_exp_f32 v248, v190
  ds_read_b128 v[36:39], v3 offset:36864
  v_add_f32 v191, v191, v228
  v_exp_f32 v249, v191
  s_nop 0
  v_cvt_pk_bf16_f32 v215, v248, v249
  ds_read_b128 v[40:43], v4 offset:36864
  ds_read_b128 v[44:47], v5 offset:36864
  s_waitcnt lgkmcnt(4)
  v_mfma_f32_16x16x32_bf16 v[176:179], v[16:19], v[80:83], v[224:227]
  v_add_f32 v192, v192, v224
  v_exp_f32 v14, v192
  ds_read_b64_tr_b16 v[48:49], v6 offset:0
  v_mfma_f32_16x16x32_bf16 v[184:187], v[16:19], v[96:99], v[228:231]
  ds_read_b64_tr_b16 v[50:51], v6 offset:4096
  v_mfma_f32_16x16x32_bf16 v[176:179], v[20:23], v[84:87], v[176:179]
  v_add_f32 v193, v193, v224
  v_exp_f32 v15, v193
  ds_read_b64_tr_b16 v[52:53], v7 offset:0
  v_mfma_f32_16x16x32_bf16 v[184:187], v[20:23], v[100:103], v[184:187]
  v_cvt_pk_bf16_f32 v216, v14, v15
  ds_read_b64_tr_b16 v[54:55], v7 offset:4096
  v_mfma_f32_16x16x32_bf16 v[176:179], v[24:27], v[88:91], v[176:179]
  v_add_f32 v194, v194, v224
  v_exp_f32 v248, v194
  ds_read_b64_tr_b16 v[56:57], v8 offset:0
  v_mfma_f32_16x16x32_bf16 v[184:187], v[24:27], v[104:107], v[184:187]
  ds_read_b64_tr_b16 v[58:59], v8 offset:4096
  v_mfma_f32_16x16x32_bf16 v[176:179], v[28:31], v[92:95], v[176:179]
  v_add_f32 v195, v195, v224
  v_exp_f32 v249, v195
  ds_read_b64_tr_b16 v[60:61], v9 offset:0
  v_mfma_f32_16x16x32_bf16 v[184:187], v[28:31], v[108:111], v[184:187]
  v_cvt_pk_bf16_f32 v217, v248, v249
  ds_read_b64_tr_b16 v[62:63], v9 offset:4096
  s_waitcnt lgkmcnt(6)
  v_mfma_f32_16x16x32_bf16 v[180:183], v[32:35], v[80:83], v[224:227]
  v_add_f32 v196, v196, v224
  v_exp_f32 v244, v196
  v_or_b32 v252, v216, v217
  ds_read_b64_tr_b16 v[64:65], v10 offset:0
  v_mfma_f32_16x16x32_bf16 v[188:191], v[32:35], v[96:99], v[228:231]
  ds_read_b64_tr_b16 v[66:67], v10 offset:4096
  v_mfma_f32_16x16x32_bf16 v[180:183], v[36:39], v[84:87], v[180:183]
  v_add_f32 v197, v197, v224
  v_exp_f32 v245, v197
  ds_read_b64_tr_b16 v[68:69], v11 offset:0
  v_mfma_f32_16x16x32_bf16 v[188:191], v[36:39], v[100:103], v[188:191]
  v_cvt_pk_bf16_f32 v218, v244, v245
  ds_read_b64_tr_b16 v[70:71], v11 offset:4096
  v_mfma_f32_16x16x32_bf16 v[180:183], v[40:43], v[88:91], v[180:183]
  v_add_f32 v198, v198, v224
  v_exp_f32 v14, v198
  ds_read_b64_tr_b16 v[72:73], v12 offset:0
  v_mfma_f32_16x16x32_bf16 v[188:191], v[40:43], v[104:107], v[188:191]
  ds_read_b64_tr_b16 v[74:75], v12 offset:4096
  v_mfma_f32_16x16x32_bf16 v[180:183], v[44:47], v[92:95], v[180:183]
  v_add_f32 v199, v199, v224
  v_exp_f32 v15, v199
  ds_read_b64_tr_b16 v[76:77], v13 offset:0
  v_mfma_f32_16x16x32_bf16 v[188:191], v[44:47], v[108:111], v[188:191]
  v_cvt_pk_bf16_f32 v219, v14, v15
  ds_read_b64_tr_b16 v[78:79], v13 offset:4096
  s_waitcnt lgkmcnt(8)
  v_mfma_f32_16x16x32_bf16 v[112:115], v[48:51], v[208:211], 0
  v_add_f32 v200, v200, v228
  v_exp_f32 v248, v200
  v_or3_b32 v252, v218, v219, v252
  v_mfma_f32_16x16x32_bf16 v[144:147], v[48:51], v[212:215], 0
  v_add_f32 v201, v201, v228
  v_exp_f32 v249, v201
  ds_read_b128 v[16:19], v2 offset:40960
  v_mfma_f32_16x16x32_bf16 v[116:119], v[52:55], v[208:211], 0
  v_mfma_f32_16x16x32_bf16 v[232:235], v[240:243], v[208:211], 0
  v_cvt_pk_bf16_f32 v220, v248, v249
  v_mfma_f32_16x16x32_bf16 v[148:151], v[52:55], v[212:215], 0
  v_add_f32 v202, v202, v228
  v_exp_f32 v244, v202
  ds_read_b128 v[20:23], v3 offset:40960
  v_mfma_f32_16x16x32_bf16 v[120:123], v[56:59], v[208:211], 0
  v_mfma_f32_16x16x32_bf16 v[152:155], v[56:59], v[212:215], 0
  v_add_f32 v203, v203, v228
  v_exp_f32 v245, v203
  ds_read_b128 v[24:27], v4 offset:40960
  v_mfma_f32_16x16x32_bf16 v[124:127], v[60:63], v[208:211], 0
  v_cvt_pk_bf16_f32 v221, v244, v245
  v_mfma_f32_16x16x32_bf16 v[156:159], v[60:63], v[212:215], 0
  v_add_f32 v204, v204, v228
  v_exp_f32 v14, v204
  v_or3_b32 v252, v220, v221, v252
  ds_read_b128 v[28:31], v5 offset:40960
  s_waitcnt lgkmcnt(4)
  v_mfma_f32_16x16x32_bf16 v[128:131], v[64:67], v[208:211], 0
  v_mfma_f32_16x16x32_bf16 v[160:163], v[64:67], v[212:215], 0
  v_add_f32 v205, v205, v228
  v_exp_f32 v15, v205
  ds_read_b128 v[32:35], v2 offset:45056
  v_mfma_f32_16x16x32_bf16 v[132:135], v[68:71], v[208:211], 0
  v_mfma_f32_16x16x32_bf16 v[236:239], v[240:243], v[212:215], 0
  v_cvt_pk_bf16_f32 v222, v14, v15
  v_add_f32 v206, v206, v228
  v_exp_f32 v248, v206
  v_mfma_f32_16x16x32_bf16 v[164:167], v[68:71], v[212:215], 0
  v_add_f32 v207, v207, v228
  v_exp_f32 v249, v207
  ds_read_b128 v[36:39], v3 offset:45056
  v_mfma_f32_16x16x32_bf16 v[136:139], v[72:75], v[208:211], 0
  v_cvt_pk_bf16_f32 v223, v248, v249
  v_mfma_f32_16x16x32_bf16 v[168:171], v[72:75], v[212:215], 0
  v_or3_b32 v252, v222, v223, v252
  ds_read_b128 v[40:43], v4 offset:45056
  v_mfma_f32_16x16x32_bf16 v[140:143], v[76:79], v[208:211], 0
  v_and_b32 v252, 0x40004000, v252
  v_mfma_f32_16x16x32_bf16 v[172:175], v[76:79], v[212:215], 0
  v_cmp_ne_u32 vcc, 0, v252
  ds_read_b128 v[44:47], v5 offset:45056
  s_cbranch_vccnz RS_7
RB_8:
  s_waitcnt lgkmcnt(4)
  v_mfma_f32_16x16x32_bf16 v[192:195], v[16:19], v[80:83], v[224:227]
  ds_read_b64_tr_b16 v[48:49], v6 offset:8192
  v_exp_f32 v14, v176
  v_mfma_f32_16x16x32_bf16 v[200:203], v[16:19], v[96:99], v[228:231]
  ds_read_b64_tr_b16 v[50:51], v6 offset:12288
  v_mfma_f32_16x16x32_bf16 v[192:195], v[20:23], v[84:87], v[192:195]
  ds_read_b64_tr_b16 v[52:53], v7 offset:8192
  v_exp_f32 v15, v177
  v_mfma_f32_16x16x32_bf16 v[200:203], v[20:23], v[100:103], v[200:203]
  ds_read_b64_tr_b16 v[54:55], v7 offset:12288
  v_cvt_pk_bf16_f32 v208, v14, v15
  v_mfma_f32_16x16x32_bf16 v[192:195], v[24:27], v[88:91], v[192:195]
  ds_read_b64_tr_b16 v[56:57], v8 offset:8192
  v_exp_f32 v248, v178
  v_mfma_f32_16x16x32_bf16 v[200:203], v[24:27], v[104:107], v[200:203]
  ds_read_b64_tr_b16 v[58:59], v8 offset:12288
  v_mfma_f32_16x16x32_bf16 v[192:195], v[28:31], v[92:95], v[192:195]
  ds_read_b64_tr_b16 v[60:61], v9 offset:8192
  v_exp_f32 v249, v179
  v_mfma_f32_16x16x32_bf16 v[200:203], v[28:31], v[108:111], v[200:203]
  ds_read_b64_tr_b16 v[62:63], v9 offset:12288
  v_cvt_pk_bf16_f32 v209, v248, v249
  s_waitcnt lgkmcnt(6)
  v_mfma_f32_16x16x32_bf16 v[196:199], v[32:35], v[80:83], v[224:227]
  ds_read_b64_tr_b16 v[64:65], v10 offset:8192
  v_exp_f32 v244, v180
  v_or_b32 v252, v208, v209
  v_mfma_f32_16x16x32_bf16 v[204:207], v[32:35], v[96:99], v[228:231]
  ds_read_b64_tr_b16 v[66:67], v10 offset:12288
  v_mfma_f32_16x16x32_bf16 v[196:199], v[36:39], v[84:87], v[196:199]
  ds_read_b64_tr_b16 v[68:69], v11 offset:8192
  v_exp_f32 v245, v181
  v_mfma_f32_16x16x32_bf16 v[204:207], v[36:39], v[100:103], v[204:207]
  ds_read_b64_tr_b16 v[70:71], v11 offset:12288
  v_cvt_pk_bf16_f32 v210, v244, v245
  v_mfma_f32_16x16x32_bf16 v[196:199], v[40:43], v[88:91], v[196:199]
  ds_read_b64_tr_b16 v[72:73], v12 offset:8192
  v_exp_f32 v14, v182
  v_mfma_f32_16x16x32_bf16 v[204:207], v[40:43], v[104:107], v[204:207]
  ds_read_b64_tr_b16 v[74:75], v12 offset:12288
  v_mfma_f32_16x16x32_bf16 v[196:199], v[44:47], v[92:95], v[196:199]
  ds_read_b64_tr_b16 v[76:77], v13 offset:8192
  v_exp_f32 v15, v183
  v_mfma_f32_16x16x32_bf16 v[204:207], v[44:47], v[108:111], v[204:207]
  ds_read_b64_tr_b16 v[78:79], v13 offset:12288
  v_cvt_pk_bf16_f32 v211, v14, v15
  s_waitcnt lgkmcnt(8)
  v_mfma_f32_16x16x32_bf16 v[112:115], v[48:51], v[216:219], v[112:115]
  s_barrier
  s_mov_b32 s8, 0x10000
  v_add_u32 v2, s8, v2
  v_add_u32 v3, s8, v3
  v_add_u32 v4, s8, v4
  v_add_u32 v5, s8, v5
  v_exp_f32 v248, v184
  v_or3_b32 v252, v210, v211, v252
  v_mfma_f32_16x16x32_bf16 v[144:147], v[48:51], v[220:223], v[144:147]
  ds_read_b128 v[16:19], v2 offset:0
  v_exp_f32 v249, v185
  v_mfma_f32_16x16x32_bf16 v[116:119], v[52:55], v[216:219], v[116:119]
  v_mfma_f32_16x16x32_bf16 v[232:235], v[240:243], v[216:219], v[232:235]
  v_cvt_pk_bf16_f32 v212, v248, v249
  v_mfma_f32_16x16x32_bf16 v[148:151], v[52:55], v[220:223], v[148:151]
  ds_read_b128 v[20:23], v3 offset:0
  v_exp_f32 v244, v186
  v_mfma_f32_16x16x32_bf16 v[120:123], v[56:59], v[216:219], v[120:123]
  v_mfma_f32_16x16x32_bf16 v[152:155], v[56:59], v[220:223], v[152:155]
  ds_read_b128 v[24:27], v4 offset:0
  v_exp_f32 v245, v187
  v_mfma_f32_16x16x32_bf16 v[124:127], v[60:63], v[216:219], v[124:127]
  v_cvt_pk_bf16_f32 v213, v244, v245
  v_mfma_f32_16x16x32_bf16 v[156:159], v[60:63], v[220:223], v[156:159]
  ds_read_b128 v[28:31], v5 offset:0
  v_exp_f32 v14, v188
  v_or3_b32 v252, v212, v213, v252
  s_waitcnt lgkmcnt(4)
  v_mfma_f32_16x16x32_bf16 v[128:131], v[64:67], v[216:219], v[128:131]
  v_mfma_f32_16x16x32_bf16 v[160:163], v[64:67], v[220:223], v[160:163]
  ds_read_b128 v[32:35], v2 offset:4096
  v_exp_f32 v15, v189
  v_mfma_f32_16x16x32_bf16 v[132:135], v[68:71], v[216:219], v[132:135]
  v_mfma_f32_16x16x32_bf16 v[236:239], v[240:243], v[220:223], v[236:239]
  v_cvt_pk_bf16_f32 v214, v14, v15
  v_exp_f32 v248, v190
  v_mfma_f32_16x16x32_bf16 v[164:167], v[68:71], v[220:223], v[164:167]
  ds_read_b128 v[36:39], v3 offset:4096
  v_exp_f32 v249, v191
  v_mfma_f32_16x16x32_bf16 v[136:139], v[72:75], v[216:219], v[136:139]
  v_cvt_pk_bf16_f32 v215, v248, v249
  v_mfma_f32_16x16x32_bf16 v[168:171], v[72:75], v[220:223], v[168:171]
  ds_read_b128 v[40:43], v4 offset:4096
  v_or3_b32 v252, v214, v215, v252
  v_mfma_f32_16x16x32_bf16 v[140:143], v[76:79], v[216:219], v[140:143]
  v_and_b32 v252, 0x40004000, v252
  v_mfma_f32_16x16x32_bf16 v[172:175], v[76:79], v[220:223], v[172:175]
  ds_read_b128 v[44:47], v5 offset:4096
  v_cmp_ne_u32 vcc, 0, v252
  s_cbranch_vccnz RS_9
RB_10:
  s_waitcnt lgkmcnt(4)
  v_mfma_f32_16x16x32_bf16 v[176:179], v[16:19], v[80:83], v[224:227]
  v_exp_f32 v14, v192
  ds_read_b64_tr_b16 v[48:49], v6 offset:32768
  v_mfma_f32_16x16x32_bf16 v[184:187], v[16:19], v[96:99], v[228:231]
  ds_read_b64_tr_b16 v[50:51], v6 offset:36864
  v_mfma_f32_16x16x32_bf16 v[176:179], v[20:23], v[84:87], v[176:179]
  v_exp_f32 v15, v193
  ds_read_b64_tr_b16 v[52:53], v7 offset:32768
  v_mfma_f32_16x16x32_bf16 v[184:187], v[20:23], v[100:103], v[184:187]
  v_cvt_pk_bf16_f32 v216, v14, v15
  ds_read_b64_tr_b16 v[54:55], v7 offset:36864
  v_mfma_f32_16x16x32_bf16 v[176:179], v[24:27], v[88:91], v[176:179]
  v_exp_f32 v248, v194
  ds_read_b64_tr_b16 v[56:57], v8 offset:32768
  v_mfma_f32_16x16x32_bf16 v[184:187], v[24:27], v[104:107], v[184:187]
  ds_read_b64_tr_b16 v[58:59], v8 offset:36864
  v_mfma_f32_16x16x32_bf16 v[176:179], v[28:31], v[92:95], v[176:179]
  v_exp_f32 v249, v195
  ds_read_b64_tr_b16 v[60:61], v9 offset:32768
  v_mfma_f32_16x16x32_bf16 v[184:187], v[28:31], v[108:111], v[184:187]
  v_cvt_pk_bf16_f32 v217, v248, v249
  ds_read_b64_tr_b16 v[62:63], v9 offset:36864
  s_waitcnt lgkmcnt(6)
  v_mfma_f32_16x16x32_bf16 v[180:183], v[32:35], v[80:83], v[224:227]
  v_exp_f32 v244, v196
  v_or_b32 v252, v216, v217
  ds_read_b64_tr_b16 v[64:65], v10 offset:32768
  v_mfma_f32_16x16x32_bf16 v[188:191], v[32:35], v[96:99], v[228:231]
  ds_read_b64_tr_b16 v[66:67], v10 offset:36864
  v_mfma_f32_16x16x32_bf16 v[180:183], v[36:39], v[84:87], v[180:183]
  v_exp_f32 v245, v197
  ds_read_b64_tr_b16 v[68:69], v11 offset:32768
  v_mfma_f32_16x16x32_bf16 v[188:191], v[36:39], v[100:103], v[188:191]
  v_cvt_pk_bf16_f32 v218, v244, v245
  ds_read_b64_tr_b16 v[70:71], v11 offset:36864
  v_mfma_f32_16x16x32_bf16 v[180:183], v[40:43], v[88:91], v[180:183]
  v_exp_f32 v14, v198
  ds_read_b64_tr_b16 v[72:73], v12 offset:32768
  v_mfma_f32_16x16x32_bf16 v[188:191], v[40:43], v[104:107], v[188:191]
  ds_read_b64_tr_b16 v[74:75], v12 offset:36864
  v_mfma_f32_16x16x32_bf16 v[180:183], v[44:47], v[92:95], v[180:183]
  v_exp_f32 v15, v199
  ds_read_b64_tr_b16 v[76:77], v13 offset:32768
  v_mfma_f32_16x16x32_bf16 v[188:191], v[44:47], v[108:111], v[188:191]
  v_cvt_pk_bf16_f32 v219, v14, v15
  ds_read_b64_tr_b16 v[78:79], v13 offset:36864
  s_waitcnt lgkmcnt(8)
  v_mfma_f32_16x16x32_bf16 v[112:115], v[48:51], v[208:211], v[112:115]
  v_exp_f32 v248, v200
  v_or3_b32 v252, v218, v219, v252
  v_mfma_f32_16x16x32_bf16 v[144:147], v[48:51], v[212:215], v[144:147]
  v_exp_f32 v249, v201
  ds_read_b128 v[16:19], v2 offset:8192
  v_mfma_f32_16x16x32_bf16 v[116:119], v[52:55], v[208:211], v[116:119]
  v_mfma_f32_16x16x32_bf16 v[232:235], v[240:243], v[208:211], v[232:235]
  v_cvt_pk_bf16_f32 v220, v248, v249
  v_mfma_f32_16x16x32_bf16 v[148:151], v[52:55], v[212:215], v[148:151]
  v_exp_f32 v244, v202
  ds_read_b128 v[20:23], v3 offset:8192
  v_mfma_f32_16x16x32_bf16 v[120:123], v[56:59], v[208:211], v[120:123]
  v_mfma_f32_16x16x32_bf16 v[152:155], v[56:59], v[212:215], v[152:155]
  v_exp_f32 v245, v203
  ds_read_b128 v[24:27], v4 offset:8192
  v_mfma_f32_16x16x32_bf16 v[124:127], v[60:63], v[208:211], v[124:127]
  v_cvt_pk_bf16_f32 v221, v244, v245
  v_mfma_f32_16x16x32_bf16 v[156:159], v[60:63], v[212:215], v[156:159]
  v_exp_f32 v14, v204
  v_or3_b32 v252, v220, v221, v252
  ds_read_b128 v[28:31], v5 offset:8192
  s_waitcnt lgkmcnt(4)
  v_mfma_f32_16x16x32_bf16 v[128:131], v[64:67], v[208:211], v[128:131]
  v_mfma_f32_16x16x32_bf16 v[160:163], v[64:67], v[212:215], v[160:163]
  v_exp_f32 v15, v205
  ds_read_b128 v[32:35], v2 offset:12288
  v_mfma_f32_16x16x32_bf16 v[132:135], v[68:71], v[208:211], v[132:135]
  v_mfma_f32_16x16x32_bf16 v[236:239], v[240:243], v[212:215], v[236:239]
  v_cvt_pk_bf16_f32 v222, v14, v15
  v_exp_f32 v248, v206
  v_mfma_f32_16x16x32_bf16 v[164:167], v[68:71], v[212:215], v[164:167]
  v_exp_f32 v249, v207
  ds_read_b128 v[36:39], v3 offset:12288
  v_mfma_f32_16x16x32_bf16 v[136:139], v[72:75], v[208:211], v[136:139]
  v_cvt_pk_bf16_f32 v223, v248, v249
  v_mfma_f32_16x16x32_bf16 v[168:171], v[72:75], v[212:215], v[168:171]
  v_or3_b32 v252, v222, v223, v252
  ds_read_b128 v[40:43], v4 offset:12288
  v_mfma_f32_16x16x32_bf16 v[140:143], v[76:79], v[208:211], v[140:143]
  v_and_b32 v252, 0x40004000, v252
  v_mfma_f32_16x16x32_bf16 v[172:175], v[76:79], v[212:215], v[172:175]
  v_cmp_ne_u32 vcc, 0, v252
  ds_read_b128 v[44:47], v5 offset:12288
  s_cbranch_vccnz RS_11
RB_12:
  s_waitcnt lgkmcnt(4)
  v_mfma_f32_16x16x32_bf16 v[192:195], v[16:19], v[80:83], v[224:227]
  ds_read_b64_tr_b16 v[48:49], v6 offset:40960
  v_exp_f32 v14, v176
  v_mfma_f32_16x16x32_bf16 v[200:203], v[16:19], v[96:99], v[228:231]
  ds_read_b64_tr_b16 v[50:51], v6 offset:45056
  v_mfma_f32_16x16x32_bf16 v[192:195], v[20:23], v[84:87], v[192:195]
  ds_read_b64_tr_b16 v[52:53], v7 offset:40960
  v_exp_f32 v15, v177
  v_mfma_f32_16x16x32_bf16 v[200:203], v[20:23], v[100:103], v[200:203]
  ds_read_b64_tr_b16 v[54:55], v7 offset:45056
  v_cvt_pk_bf16_f32 v208, v14, v15
  v_mfma_f32_16x16x32_bf16 v[192:195], v[24:27], v[88:91], v[192:195]
  ds_read_b64_tr_b16 v[56:57], v8 offset:40960
  v_exp_f32 v248, v178
  v_mfma_f32_16x16x32_bf16 v[200:203], v[24:27], v[104:107], v[200:203]
  ds_read_b64_tr_b16 v[58:59], v8 offset:45056
  v_mfma_f32_16x16x32_bf16 v[192:195], v[28:31], v[92:95], v[192:195]
  ds_read_b64_tr_b16 v[60:61], v9 offset:40960
  v_exp_f32 v249, v179
  v_mfma_f32_16x16x32_bf16 v[200:203], v[28:31], v[108:111], v[200:203]
  ds_read_b64_tr_b16 v[62:63], v9 offset:45056
  v_cvt_pk_bf16_f32 v209, v248, v249
  s_waitcnt lgkmcnt(6)
  v_mfma_f32_16x16x32_bf16 v[196:199], v[32:35], v[80:83], v[224:227]
  ds_read_b64_tr_b16 v[64:65], v10 offset:40960
  v_exp_f32 v244, v180
  v_or_b32 v252, v208, v209
  v_mfma_f32_16x16x32_bf16 v[204:207], v[32:35], v[96:99], v[228:231]
  ds_read_b64_tr_b16 v[66:67], v10 offset:45056
  v_mfma_f32_16x16x32_bf16 v[196:199], v[36:39], v[84:87], v[196:199]
  ds_read_b64_tr_b16 v[68:69], v11 offset:40960
  v_exp_f32 v245, v181
  v_mfma_f32_16x16x32_bf16 v[204:207], v[36:39], v[100:103], v[204:207]
  ds_read_b64_tr_b16 v[70:71], v11 offset:45056
  v_cvt_pk_bf16_f32 v210, v244, v245
  v_mfma_f32_16x16x32_bf16 v[196:199], v[40:43], v[88:91], v[196:199]
  ds_read_b64_tr_b16 v[72:73], v12 offset:40960
  v_exp_f32 v14, v182
  v_mfma_f32_16x16x32_bf16 v[204:207], v[40:43], v[104:107], v[204:207]
  ds_read_b64_tr_b16 v[74:75], v12 offset:45056
  v_mfma_f32_16x16x32_bf16 v[196:199], v[44:47], v[92:95], v[196:199]
  ds_read_b64_tr_b16 v[76:77], v13 offset:40960
  v_exp_f32 v15, v183
  v_mfma_f32_16x16x32_bf16 v[204:207], v[44:47], v[108:111], v[204:207]
  ds_read_b64_tr_b16 v[78:79], v13 offset:45056
  v_cvt_pk_bf16_f32 v211, v14, v15
  s_waitcnt lgkmcnt(8)
  v_mfma_f32_16x16x32_bf16 v[112:115], v[48:51], v[216:219], v[112:115]
  s_barrier
  v_exp_f32 v248, v184
  v_or3_b32 v252, v210, v211, v252
  v_mfma_f32_16x16x32_bf16 v[144:147], v[48:51], v[220:223], v[144:147]
  ds_read_b128 v[16:19], v2 offset:32768
  v_exp_f32 v249, v185
  v_mfma_f32_16x16x32_bf16 v[116:119], v[52:55], v[216:219], v[116:119]
  v_mfma_f32_16x16x32_bf16 v[232:235], v[240:243], v[216:219], v[232:235]
  v_cvt_pk_bf16_f32 v212, v248, v249
  v_mfma_f32_16x16x32_bf16 v[148:151], v[52:55], v[220:223], v[148:151]
  ds_read_b128 v[20:23], v3 offset:32768
  v_exp_f32 v244, v186
  v_mfma_f32_16x16x32_bf16 v[120:123], v[56:59], v[216:219], v[120:123]
  v_mfma_f32_16x16x32_bf16 v[152:155], v[56:59], v[220:223], v[152:155]
  ds_read_b128 v[24:27], v4 offset:32768
  v_exp_f32 v245, v187
  v_mfma_f32_16x16x32_bf16 v[124:127], v[60:63], v[216:219], v[124:127]
  v_cvt_pk_bf16_f32 v213, v244, v245
  v_mfma_f32_16x16x32_bf16 v[156:159], v[60:63], v[220:223], v[156:159]
  ds_read_b128 v[28:31], v5 offset:32768
  v_exp_f32 v14, v188
  v_or3_b32 v252, v212, v213, v252
  s_waitcnt lgkmcnt(4)
  v_mfma_f32_16x16x32_bf16 v[128:131], v[64:67], v[216:219], v[128:131]
  v_mfma_f32_16x16x32_bf16 v[160:163], v[64:67], v[220:223], v[160:163]
  ds_read_b128 v[32:35], v2 offset:36864
  v_exp_f32 v15, v189
  v_mfma_f32_16x16x32_bf16 v[132:135], v[68:71], v[216:219], v[132:135]
  v_mfma_f32_16x16x32_bf16 v[236:239], v[240:243], v[220:223], v[236:239]
  v_cvt_pk_bf16_f32 v214, v14, v15
  v_exp_f32 v248, v190
  v_mfma_f32_16x16x32_bf16 v[164:167], v[68:71], v[220:223], v[164:167]
  ds_read_b128 v[36:39], v3 offset:36864
  v_exp_f32 v249, v191
  v_mfma_f32_16x16x32_bf16 v[136:139], v[72:75], v[216:219], v[136:139]
  v_cvt_pk_bf16_f32 v215, v248, v249
  v_mfma_f32_16x16x32_bf16 v[168:171], v[72:75], v[220:223], v[168:171]
  ds_read_b128 v[40:43], v4 offset:36864
  v_or3_b32 v252, v214, v215, v252
  v_mfma_f32_16x16x32_bf16 v[140:143], v[76:79], v[216:219], v[140:143]
  v_and_b32 v252, 0x40004000, v252
  v_mfma_f32_16x16x32_bf16 v[172:175], v[76:79], v[220:223], v[172:175]
  ds_read_b128 v[44:47], v5 offset:36864
  v_cmp_ne_u32 vcc, 0, v252
  s_cbranch_vccnz RS_13
RB_14:
  s_mov_b32 s9, 0x10000
  v_add_u32 v6, s9, v6
  v_add_u32 v7, s9, v7
  v_add_u32 v8, s9, v8
  v_add_u32 v9, s9, v9
  v_add_u32 v10, s9, v10
  v_add_u32 v11, s9, v11
  v_add_u32 v12, s9, v12
  v_add_u32 v13, s9, v13
  s_waitcnt lgkmcnt(4)
  v_mfma_f32_16x16x32_bf16 v[176:179], v[16:19], v[80:83], v[224:227]
  v_exp_f32 v14, v192
  ds_read_b64_tr_b16 v[48:49], v6 offset:0
  v_mfma_f32_16x16x32_bf16 v[184:187], v[16:19], v[96:99], v[228:231]
  ds_read_b64_tr_b16 v[50:51], v6 offset:4096
  v_mfma_f32_16x16x32_bf16 v[176:179], v[20:23], v[84:87], v[176:179]
  v_exp_f32 v15, v193
  ds_read_b64_tr_b16 v[52:53], v7 offset:0
  v_mfma_f32_16x16x32_bf16 v[184:187], v[20:23], v[100:103], v[184:187]
  v_cvt_pk_bf16_f32 v216, v14, v15
  ds_read_b64_tr_b16 v[54:55], v7 offset:4096
  v_mfma_f32_16x16x32_bf16 v[176:179], v[24:27], v[88:91], v[176:179]
  v_exp_f32 v248, v194
  ds_read_b64_tr_b16 v[56:57], v8 offset:0
  v_mfma_f32_16x16x32_bf16 v[184:187], v[24:27], v[104:107], v[184:187]
  ds_read_b64_tr_b16 v[58:59], v8 offset:4096
  v_mfma_f32_16x16x32_bf16 v[176:179], v[28:31], v[92:95], v[176:179]
  v_exp_f32 v249, v195
  ds_read_b64_tr_b16 v[60:61], v9 offset:0
  v_mfma_f32_16x16x32_bf16 v[184:187], v[28:31], v[108:111], v[184:187]
  v_cvt_pk_bf16_f32 v217, v248, v249
  ds_read_b64_tr_b16 v[62:63], v9 offset:4096
  s_waitcnt lgkmcnt(6)
  v_mfma_f32_16x16x32_bf16 v[180:183], v[32:35], v[80:83], v[224:227]
  v_exp_f32 v244, v196
  v_or_b32 v252, v216, v217
  ds_read_b64_tr_b16 v[64:65], v10 offset:0
  v_mfma_f32_16x16x32_bf16 v[188:191], v[32:35], v[96:99], v[228:231]
  ds_read_b64_tr_b16 v[66:67], v10 offset:4096
  v_mfma_f32_16x16x32_bf16 v[180:183], v[36:39], v[84:87], v[180:183]
  v_exp_f32 v245, v197
  ds_read_b64_tr_b16 v[68:69], v11 offset:0
  v_mfma_f32_16x16x32_bf16 v[188:191], v[36:39], v[100:103], v[188:191]
  v_cvt_pk_bf16_f32 v218, v244, v245
  ds_read_b64_tr_b16 v[70:71], v11 offset:4096
  v_mfma_f32_16x16x32_bf16 v[180:183], v[40:43], v[88:91], v[180:183]
  v_exp_f32 v14, v198
  ds_read_b64_tr_b16 v[72:73], v12 offset:0
  v_mfma_f32_16x16x32_bf16 v[188:191], v[40:43], v[104:107], v[188:191]
  ds_read_b64_tr_b16 v[74:75], v12 offset:4096
  v_mfma_f32_16x16x32_bf16 v[180:183], v[44:47], v[92:95], v[180:183]
  v_exp_f32 v15, v199
  ds_read_b64_tr_b16 v[76:77], v13 offset:0
  v_mfma_f32_16x16x32_bf16 v[188:191], v[44:47], v[108:111], v[188:191]
  v_cvt_pk_bf16_f32 v219, v14, v15
  ds_read_b64_tr_b16 v[78:79], v13 offset:4096
  s_waitcnt lgkmcnt(8)
  v_mfma_f32_16x16x32_bf16 v[112:115], v[48:51], v[208:211], v[112:115]
  v_exp_f32 v248, v200
  v_or3_b32 v252, v218, v219, v252
  v_mfma_f32_16x16x32_bf16 v[144:147], v[48:51], v[212:215], v[144:147]
  v_exp_f32 v249, v201
  ds_read_b128 v[16:19], v2 offset:40960
  v_mfma_f32_16x16x32_bf16 v[116:119], v[52:55], v[208:211], v[116:119]
  v_mfma_f32_16x16x32_bf16 v[232:235], v[240:243], v[208:211], v[232:235]
  v_cvt_pk_bf16_f32 v220, v248, v249
  v_mfma_f32_16x16x32_bf16 v[148:151], v[52:55], v[212:215], v[148:151]
  v_exp_f32 v244, v202
  ds_read_b128 v[20:23], v3 offset:40960
  v_mfma_f32_16x16x32_bf16 v[120:123], v[56:59], v[208:211], v[120:123]
  v_mfma_f32_16x16x32_bf16 v[152:155], v[56:59], v[212:215], v[152:155]
  v_exp_f32 v245, v203
  ds_read_b128 v[24:27], v4 offset:40960
  v_mfma_f32_16x16x32_bf16 v[124:127], v[60:63], v[208:211], v[124:127]
  v_cvt_pk_bf16_f32 v221, v244, v245
  v_mfma_f32_16x16x32_bf16 v[156:159], v[60:63], v[212:215], v[156:159]
  v_exp_f32 v14, v204
  v_or3_b32 v252, v220, v221, v252
  ds_read_b128 v[28:31], v5 offset:40960
  s_waitcnt lgkmcnt(4)
  v_mfma_f32_16x16x32_bf16 v[128:131], v[64:67], v[208:211], v[128:131]
  v_mfma_f32_16x16x32_bf16 v[160:163], v[64:67], v[212:215], v[160:163]
  v_exp_f32 v15, v205
  ds_read_b128 v[32:35], v2 offset:45056
  v_mfma_f32_16x16x32_bf16 v[132:135], v[68:71], v[208:211], v[132:135]
  v_mfma_f32_16x16x32_bf16 v[236:239], v[240:243], v[212:215], v[236:239]
  v_cvt_pk_bf16_f32 v222, v14, v15
  v_exp_f32 v248, v206
  v_mfma_f32_16x16x32_bf16 v[164:167], v[68:71], v[212:215], v[164:167]
  v_exp_f32 v249, v207
  ds_read_b128 v[36:39], v3 offset:45056
  v_mfma_f32_16x16x32_bf16 v[136:139], v[72:75], v[208:211], v[136:139]
  v_cvt_pk_bf16_f32 v223, v248, v249
  v_mfma_f32_16x16x32_bf16 v[168:171], v[72:75], v[212:215], v[168:171]
  v_or3_b32 v252, v222, v223, v252
  ds_read_b128 v[40:43], v4 offset:45056
  v_mfma_f32_16x16x32_bf16 v[140:143], v[76:79], v[208:211], v[140:143]
  v_and_b32 v252, 0x40004000, v252
  v_mfma_f32_16x16x32_bf16 v[172:175], v[76:79], v[212:215], v[172:175]
  v_cmp_ne_u32 vcc, 0, v252
  ds_read_b128 v[44:47], v5 offset:45056
  s_cbranch_vccnz RS_15
RB_16:
  s_waitcnt lgkmcnt(4)
  v_mfma_f32_16x16x32_bf16 v[192:195], v[16:19], v[80:83], v[224:227]
  ds_read_b64_tr_b16 v[48:49], v6 offset:8192
  v_exp_f32 v14, v176
  v_mfma_f32_16x16x32_bf16 v[200:203], v[16:19], v[96:99], v[228:231]
  ds_read_b64_tr_b16 v[50:51], v6 offset:12288
  v_mfma_f32_16x16x32_bf16 v[192:195], v[20:23], v[84:87], v[192:195]
  ds_read_b64_tr_b16 v[52:53], v7 offset:8192
  v_exp_f32 v15, v177
  v_mfma_f32_16x16x32_bf16 v[200:203], v[20:23], v[100:103], v[200:203]
  ds_read_b64_tr_b16 v[54:55], v7 offset:12288
  v_cvt_pk_bf16_f32 v208, v14, v15
  v_mfma_f32_16x16x32_bf16 v[192:195], v[24:27], v[88:91], v[192:195]
  ds_read_b64_tr_b16 v[56:57], v8 offset:8192
  v_exp_f32 v248, v178
  v_mfma_f32_16x16x32_bf16 v[200:203], v[24:27], v[104:107], v[200:203]
  ds_read_b64_tr_b16 v[58:59], v8 offset:12288
  v_mfma_f32_16x16x32_bf16 v[192:195], v[28:31], v[92:95], v[192:195]
  ds_read_b64_tr_b16 v[60:61], v9 offset:8192
  v_exp_f32 v249, v179
  v_mfma_f32_16x16x32_bf16 v[200:203], v[28:31], v[108:111], v[200:203]
  ds_read_b64_tr_b16 v[62:63], v9 offset:12288
  v_cvt_pk_bf16_f32 v209, v248, v249
  s_waitcnt lgkmcnt(6)
  v_mfma_f32_16x16x32_bf16 v[196:199], v[32:35], v[80:83], v[224:227]
  ds_read_b64_tr_b16 v[64:65], v10 offset:8192
  v_exp_f32 v244, v180
  v_or_b32 v252, v208, v209
  v_mfma_f32_16x16x32_bf16 v[204:207], v[32:35], v[96:99], v[228:231]
  ds_read_b64_tr_b16 v[66:67], v10 offset:12288
  v_mfma_f32_16x16x32_bf16 v[196:199], v[36:39], v[84:87], v[196:199]
  ds_read_b64_tr_b16 v[68:69], v11 offset:8192
  v_exp_f32 v245, v181
  v_mfma_f32_16x16x32_bf16 v[204:207], v[36:39], v[100:103], v[204:207]
  ds_read_b64_tr_b16 v[70:71], v11 offset:12288
  v_cvt_pk_bf16_f32 v210, v244, v245
  v_mfma_f32_16x16x32_bf16 v[196:199], v[40:43], v[88:91], v[196:199]
  ds_read_b64_tr_b16 v[72:73], v12 offset:8192
  v_exp_f32 v14, v182
  v_mfma_f32_16x16x32_bf16 v[204:207], v[40:43], v[104:107], v[204:207]
  ds_read_b64_tr_b16 v[74:75], v12 offset:12288
  v_mfma_f32_16x16x32_bf16 v[196:199], v[44:47], v[92:95], v[196:199]
  ds_read_b64_tr_b16 v[76:77], v13 offset:8192
  v_exp_f32 v15, v183
  v_mfma_f32_16x16x32_bf16 v[204:207], v[44:47], v[108:111], v[204:207]
  ds_read_b64_tr_b16 v[78:79], v13 offset:12288
  v_cvt_pk_bf16_f32 v211, v14, v15
  s_waitcnt lgkmcnt(8)
  v_mfma_f32_16x16x32_bf16 v[112:115], v[48:51], v[216:219], v[112:115]
  s_barrier
  s_mov_b32 s8, 0x10000
  v_add_u32 v2, s8, v2
  v_add_u32 v3, s8, v3
  v_add_u32 v4, s8, v4
  v_add_u32 v5, s8, v5
  v_exp_f32 v248, v184
  v_or3_b32 v252, v210, v211, v252
  v_mfma_f32_16x16x32_bf16 v[144:147], v[48:51], v[220:223], v[144:147]
  ds_read_b128 v[16:19], v2 offset:0
  v_exp_f32 v249, v185
  v_mfma_f32_16x16x32_bf16 v[116:119], v[52:55], v[216:219], v[116:119]
  v_mfma_f32_16x16x32_bf16 v[232:235], v[240:243], v[216:219], v[232:235]
  v_cvt_pk_bf16_f32 v212, v248, v249
  v_mfma_f32_16x16x32_bf16 v[148:151], v[52:55], v[220:223], v[148:151]
  ds_read_b128 v[20:23], v3 offset:0
  v_exp_f32 v244, v186
  v_mfma_f32_16x16x32_bf16 v[120:123], v[56:59], v[216:219], v[120:123]
  v_mfma_f32_16x16x32_bf16 v[152:155], v[56:59], v[220:223], v[152:155]
  ds_read_b128 v[24:27], v4 offset:0
  v_exp_f32 v245, v187
  v_mfma_f32_16x16x32_bf16 v[124:127], v[60:63], v[216:219], v[124:127]
  v_cvt_pk_bf16_f32 v213, v244, v245
  v_mfma_f32_16x16x32_bf16 v[156:159], v[60:63], v[220:223], v[156:159]
  ds_read_b128 v[28:31], v5 offset:0
  v_exp_f32 v14, v188
  v_or3_b32 v252, v212, v213, v252
  s_waitcnt lgkmcnt(4)
  v_mfma_f32_16x16x32_bf16 v[128:131], v[64:67], v[216:219], v[128:131]
  v_mfma_f32_16x16x32_bf16 v[160:163], v[64:67], v[220:223], v[160:163]
  ds_read_b128 v[32:35], v2 offset:4096
  v_exp_f32 v15, v189
  v_mfma_f32_16x16x32_bf16 v[132:135], v[68:71], v[216:219], v[132:135]
  v_mfma_f32_16x16x32_bf16 v[236:239], v[240:243], v[220:223], v[236:239]
  v_cvt_pk_bf16_f32 v214, v14, v15
  v_exp_f32 v248, v190
  v_mfma_f32_16x16x32_bf16 v[164:167], v[68:71], v[220:223], v[164:167]
  ds_read_b128 v[36:39], v3 offset:4096
  v_exp_f32 v249, v191
  v_mfma_f32_16x16x32_bf16 v[136:139], v[72:75], v[216:219], v[136:139]
  v_cvt_pk_bf16_f32 v215, v248, v249
  v_mfma_f32_16x16x32_bf16 v[168:171], v[72:75], v[220:223], v[168:171]
  ds_read_b128 v[40:43], v4 offset:4096
  v_or3_b32 v252, v214, v215, v252
  v_mfma_f32_16x16x32_bf16 v[140:143], v[76:79], v[216:219], v[140:143]
  v_and_b32 v252, 0x40004000, v252
  v_mfma_f32_16x16x32_bf16 v[172:175], v[76:79], v[220:223], v[172:175]
  ds_read_b128 v[44:47], v5 offset:4096
  v_cmp_ne_u32 vcc, 0, v252
  s_cbranch_vccnz RS_17
RB_18:
  s_waitcnt lgkmcnt(4)
  v_mfma_f32_16x16x32_bf16 v[176:179], v[16:19], v[80:83], v[224:227]
  v_exp_f32 v14, v192
  ds_read_b64_tr_b16 v[48:49], v6 offset:32768
  v_mfma_f32_16x16x32_bf16 v[184:187], v[16:19], v[96:99], v[228:231]
  ds_read_b64_tr_b16 v[50:51], v6 offset:36864
  v_mfma_f32_16x16x32_bf16 v[176:179], v[20:23], v[84:87], v[176:179]
  v_exp_f32 v15, v193
  ds_read_b64_tr_b16 v[52:53], v7 offset:32768
  v_mfma_f32_16x16x32_bf16 v[184:187], v[20:23], v[100:103], v[184:187]
  v_cvt_pk_bf16_f32 v216, v14, v15
  ds_read_b64_tr_b16 v[54:55], v7 offset:36864
  v_mfma_f32_16x16x32_bf16 v[176:179], v[24:27], v[88:91], v[176:179]
  v_exp_f32 v248, v194
  ds_read_b64_tr_b16 v[56:57], v8 offset:32768
  v_mfma_f32_16x16x32_bf16 v[184:187], v[24:27], v[104:107], v[184:187]
  ds_read_b64_tr_b16 v[58:59], v8 offset:36864
  v_mfma_f32_16x16x32_bf16 v[176:179], v[28:31], v[92:95], v[176:179]
  v_exp_f32 v249, v195
  ds_read_b64_tr_b16 v[60:61], v9 offset:32768
  v_mfma_f32_16x16x32_bf16 v[184:187], v[28:31], v[108:111], v[184:187]
  v_cvt_pk_bf16_f32 v217, v248, v249
  ds_read_b64_tr_b16 v[62:63], v9 offset:36864
  s_waitcnt lgkmcnt(6)
  v_mfma_f32_16x16x32_bf16 v[180:183], v[32:35], v[80:83], v[224:227]
  v_exp_f32 v244, v196
  v_or_b32 v252, v216, v217
  ds_read_b64_tr_b16 v[64:65], v10 offset:32768
  v_mfma_f32_16x16x32_bf16 v[188:191], v[32:35], v[96:99], v[228:231]
  ds_read_b64_tr_b16 v[66:67], v10 offset:36864
  v_mfma_f32_16x16x32_bf16 v[180:183], v[36:39], v[84:87], v[180:183]
  v_exp_f32 v245, v197
  ds_read_b64_tr_b16 v[68:69], v11 offset:32768
  v_mfma_f32_16x16x32_bf16 v[188:191], v[36:39], v[100:103], v[188:191]
  v_cvt_pk_bf16_f32 v218, v244, v245
  ds_read_b64_tr_b16 v[70:71], v11 offset:36864
  v_mfma_f32_16x16x32_bf16 v[180:183], v[40:43], v[88:91], v[180:183]
  v_exp_f32 v14, v198
  ds_read_b64_tr_b16 v[72:73], v12 offset:32768
  v_mfma_f32_16x16x32_bf16 v[188:191], v[40:43], v[104:107], v[188:191]
  ds_read_b64_tr_b16 v[74:75], v12 offset:36864
  v_mfma_f32_16x16x32_bf16 v[180:183], v[44:47], v[92:95], v[180:183]
  v_exp_f32 v15, v199
  ds_read_b64_tr_b16 v[76:77], v13 offset:32768
  v_mfma_f32_16x16x32_bf16 v[188:191], v[44:47], v[108:111], v[188:191]
  v_cvt_pk_bf16_f32 v219, v14, v15
  ds_read_b64_tr_b16 v[78:79], v13 offset:36864
  s_waitcnt lgkmcnt(8)
  v_mfma_f32_16x16x32_bf16 v[112:115], v[48:51], v[208:211], v[112:115]
  v_exp_f32 v248, v200
  v_or3_b32 v252, v218, v219, v252
  v_mfma_f32_16x16x32_bf16 v[144:147], v[48:51], v[212:215], v[144:147]
  v_exp_f32 v249, v201
  ds_read_b128 v[16:19], v2 offset:8192
  v_mfma_f32_16x16x32_bf16 v[116:119], v[52:55], v[208:211], v[116:119]
  v_mfma_f32_16x16x32_bf16 v[232:235], v[240:243], v[208:211], v[232:235]
  v_cvt_pk_bf16_f32 v220, v248, v249
  v_mfma_f32_16x16x32_bf16 v[148:151], v[52:55], v[212:215], v[148:151]
  v_exp_f32 v244, v202
  ds_read_b128 v[20:23], v3 offset:8192
  v_mfma_f32_16x16x32_bf16 v[120:123], v[56:59], v[208:211], v[120:123]
  v_mfma_f32_16x16x32_bf16 v[152:155], v[56:59], v[212:215], v[152:155]
  v_exp_f32 v245, v203
  ds_read_b128 v[24:27], v4 offset:8192
  v_mfma_f32_16x16x32_bf16 v[124:127], v[60:63], v[208:211], v[124:127]
  v_cvt_pk_bf16_f32 v221, v244, v245
  v_mfma_f32_16x16x32_bf16 v[156:159], v[60:63], v[212:215], v[156:159]
  v_exp_f32 v14, v204
  v_or3_b32 v252, v220, v221, v252
  ds_read_b128 v[28:31], v5 offset:8192
  s_waitcnt lgkmcnt(4)
  v_mfma_f32_16x16x32_bf16 v[128:131], v[64:67], v[208:211], v[128:131]
  v_mfma_f32_16x16x32_bf16 v[160:163], v[64:67], v[212:215], v[160:163]
  v_exp_f32 v15, v205
  ds_read_b128 v[32:35], v2 offset:12288
  v_mfma_f32_16x16x32_bf16 v[132:135], v[68:71], v[208:211], v[132:135]
  v_mfma_f32_16x16x32_bf16 v[236:239], v[240:243], v[212:215], v[236:239]
  v_cvt_pk_bf16_f32 v222, v14, v15
  v_exp_f32 v248, v206
  v_mfma_f32_16x16x32_bf16 v[164:167], v[68:71], v[212:215], v[164:167]
  v_exp_f32 v249, v207
  ds_read_b128 v[36:39], v3 offset:12288
  v_mfma_f32_16x16x32_bf16 v[136:139], v[72:75], v[208:211], v[136:139]
  v_cvt_pk_bf16_f32 v223, v248, v249
  v_mfma_f32_16x16x32_bf16 v[168:171], v[72:75], v[212:215], v[168:171]
  v_or3_b32 v252, v222, v223, v252
  ds_read_b128 v[40:43], v4 offset:12288
  v_mfma_f32_16x16x32_bf16 v[140:143], v[76:79], v[208:211], v[140:143]
  v_and_b32 v252, 0x40004000, v252
  v_mfma_f32_16x16x32_bf16 v[172:175], v[76:79], v[212:215], v[172:175]
  v_cmp_ne_u32 vcc, 0, v252
  ds_read_b128 v[44:47], v5 offset:12288
  s_cbranch_vccnz RS_19
RB_20:
  s_waitcnt lgkmcnt(4)
  v_mfma_f32_16x16x32_bf16 v[192:195], v[16:19], v[80:83], v[224:227]
  ds_read_b64_tr_b16 v[48:49], v6 offset:40960
  v_exp_f32 v14, v176
  v_mfma_f32_16x16x32_bf16 v[200:203], v[16:19], v[96:99], v[228:231]
  ds_read_b64_tr_b16 v[50:51], v6 offset:45056
  v_mfma_f32_16x16x32_bf16 v[192:195], v[20:23], v[84:87], v[192:195]
  ds_read_b64_tr_b16 v[52:53], v7 offset:40960
  v_exp_f32 v15, v177
  v_mfma_f32_16x16x32_bf16 v[200:203], v[20:23], v[100:103], v[200:203]
  ds_read_b64_tr_b16 v[54:55], v7 offset:45056
  v_cvt_pk_bf16_f32 v208, v14, v15
  v_mfma_f32_16x16x32_bf16 v[192:195], v[24:27], v[88:91], v[192:195]
  ds_read_b64_tr_b16 v[56:57], v8 offset:40960
  v_exp_f32 v248, v178
  v_mfma_f32_16x16x32_bf16 v[200:203], v[24:27], v[104:107], v[200:203]
  ds_read_b64_tr_b16 v[58:59], v8 offset:45056
  v_mfma_f32_16x16x32_bf16 v[192:195], v[28:31], v[92:95], v[192:195]
  ds_read_b64_tr_b16 v[60:61], v9 offset:40960
  v_exp_f32 v249, v179
  v_mfma_f32_16x16x32_bf16 v[200:203], v[28:31], v[108:111], v[200:203]
  ds_read_b64_tr_b16 v[62:63], v9 offset:45056
  v_cvt_pk_bf16_f32 v209, v248, v249
  s_waitcnt lgkmcnt(6)
  v_mfma_f32_16x16x32_bf16 v[196:199], v[32:35], v[80:83], v[224:227]
  ds_read_b64_tr_b16 v[64:65], v10 offset:40960
  v_exp_f32 v244, v180
  v_or_b32 v252, v208, v209
  v_mfma_f32_16x16x32_bf16 v[204:207], v[32:35], v[96:99], v[228:231]
  ds_read_b64_tr_b16 v[66:67], v10 offset:45056
  v_mfma_f32_16x16x32_bf16 v[196:199], v[36:39], v[84:87], v[196:199]
  ds_read_b64_tr_b16 v[68:69], v11 offset:40960
  v_exp_f32 v245, v181
  v_mfma_f32_16x16x32_bf16 v[204:207], v[36:39], v[100:103], v[204:207]
  ds_read_b64_tr_b16 v[70:71], v11 offset:45056
  v_cvt_pk_bf16_f32 v210, v244, v245
  v_mfma_f32_16x16x32_bf16 v[196:199], v[40:43], v[88:91], v[196:199]
  ds_read_b64_tr_b16 v[72:73], v12 offset:40960
  v_exp_f32 v14, v182
  v_mfma_f32_16x16x32_bf16 v[204:207], v[40:43], v[104:107], v[204:207]
  ds_read_b64_tr_b16 v[74:75], v12 offset:45056
  v_mfma_f32_16x16x32_bf16 v[196:199], v[44:47], v[92:95], v[196:199]
  ds_read_b64_tr_b16 v[76:77], v13 offset:40960
  v_exp_f32 v15, v183
  v_mfma_f32_16x16x32_bf16 v[204:207], v[44:47], v[108:111], v[204:207]
  ds_read_b64_tr_b16 v[78:79], v13 offset:45056
  v_cvt_pk_bf16_f32 v211, v14, v15
  s_waitcnt lgkmcnt(8)
  v_mfma_f32_16x16x32_bf16 v[112:115], v[48:51], v[216:219], v[112:115]
  s_barrier
  s_mov_b32 s8, 0xfffe0000
  v_add_u32 v2, s8, v2
  v_add_u32 v3, s8, v3
  v_add_u32 v4, s8, v4
  v_add_u32 v5, s8, v5
  v_exp_f32 v248, v184
  v_or3_b32 v252, v210, v211, v252
  v_mfma_f32_16x16x32_bf16 v[144:147], v[48:51], v[220:223], v[144:147]
  ds_read_b128 v[16:19], v2 offset:0
  v_exp_f32 v249, v185
  v_mfma_f32_16x16x32_bf16 v[116:119], v[52:55], v[216:219], v[116:119]
  v_mfma_f32_16x16x32_bf16 v[232:235], v[240:243], v[216:219], v[232:235]
  v_cvt_pk_bf16_f32 v212, v248, v249
  v_mfma_f32_16x16x32_bf16 v[148:151], v[52:55], v[220:223], v[148:151]
  ds_read_b128 v[20:23], v3 offset:0
  v_exp_f32 v244, v186
  v_mfma_f32_16x16x32_bf16 v[120:123], v[56:59], v[216:219], v[120:123]
  v_mfma_f32_16x16x32_bf16 v[152:155], v[56:59], v[220:223], v[152:155]
  ds_read_b128 v[24:27], v4 offset:0
  v_exp_f32 v245, v187
  v_mfma_f32_16x16x32_bf16 v[124:127], v[60:63], v[216:219], v[124:127]
  v_cvt_pk_bf16_f32 v213, v244, v245
  v_mfma_f32_16x16x32_bf16 v[156:159], v[60:63], v[220:223], v[156:159]
  ds_read_b128 v[28:31], v5 offset:0
  v_exp_f32 v14, v188
  v_or3_b32 v252, v212, v213, v252
  s_waitcnt lgkmcnt(4)
  v_mfma_f32_16x16x32_bf16 v[128:131], v[64:67], v[216:219], v[128:131]
  v_mfma_f32_16x16x32_bf16 v[160:163], v[64:67], v[220:223], v[160:163]
  ds_read_b128 v[32:35], v2 offset:4096
  v_exp_f32 v15, v189
  v_mfma_f32_16x16x32_bf16 v[132:135], v[68:71], v[216:219], v[132:135]
  v_mfma_f32_16x16x32_bf16 v[236:239], v[240:243], v[220:223], v[236:239]
  v_cvt_pk_bf16_f32 v214, v14, v15
  v_exp_f32 v248, v190
  v_mfma_f32_16x16x32_bf16 v[164:167], v[68:71], v[220:223], v[164:167]
  ds_read_b128 v[36:39], v3 offset:4096
  v_exp_f32 v249, v191
  v_mfma_f32_16x16x32_bf16 v[136:139], v[72:75], v[216:219], v[136:139]
  v_cvt_pk_bf16_f32 v215, v248, v249
  v_mfma_f32_16x16x32_bf16 v[168:171], v[72:75], v[220:223], v[168:171]
  ds_read_b128 v[40:43], v4 offset:4096
  v_or3_b32 v252, v214, v215, v252
  v_mfma_f32_16x16x32_bf16 v[140:143], v[76:79], v[216:219], v[140:143]
  v_and_b32 v252, 0x40004000, v252
  v_mfma_f32_16x16x32_bf16 v[172:175], v[76:79], v[220:223], v[172:175]
  ds_read_b128 v[44:47], v5 offset:4096
  v_cmp_ne_u32 vcc, 0, v252
  s_cbranch_vccnz RS_21
RB_22:
  s_mov_b32 s9, 0x10000
  v_add_u32 v6, s9, v6
  v_add_u32 v7, s9, v7
  v_add_u32 v8, s9, v8
  v_add_u32 v9, s9, v9
  v_add_u32 v10, s9, v10
  v_add_u32 v11, s9, v11
  v_add_u32 v12, s9, v12
  v_add_u32 v13, s9, v13
  s_waitcnt lgkmcnt(4)
  v_mfma_f32_16x16x32_bf16 v[176:179], v[16:19], v[80:83], v[224:227]
  v_exp_f32 v14, v192
  ds_read_b64_tr_b16 v[48:49], v6 offset:0
  v_mfma_f32_16x16x32_bf16 v[184:187], v[16:19], v[96:99], v[228:231]
  ds_read_b64_tr_b16 v[50:51], v6 offset:4096
  v_mfma_f32_16x16x32_bf16 v[176:179], v[20:23], v[84:87], v[176:179]
  v_exp_f32 v15, v193
  ds_read_b64_tr_b16 v[52:53], v7 offset:0
  v_mfma_f32_16x16x32_bf16 v[184:187], v[20:23], v[100:103], v[184:187]
  v_cvt_pk_bf16_f32 v216, v14, v15
  ds_read_b64_tr_b16 v[54:55], v7 offset:4096
  v_mfma_f32_16x16x32_bf16 v[176:179], v[24:27], v[88:91], v[176:179]
  v_exp_f32 v248, v194
  ds_read_b64_tr_b16 v[56:57], v8 offset:0
  v_mfma_f32_16x16x32_bf16 v[184:187], v[24:27], v[104:107], v[184:187]
  ds_read_b64_tr_b16 v[58:59], v8 offset:4096
  v_mfma_f32_16x16x32_bf16 v[176:179], v[28:31], v[92:95], v[176:179]
  v_exp_f32 v249, v195
  ds_read_b64_tr_b16 v[60:61], v9 offset:0
  v_mfma_f32_16x16x32_bf16 v[184:187], v[28:31], v[108:111], v[184:187]
  v_cvt_pk_bf16_f32 v217, v248, v249
  ds_read_b64_tr_b16 v[62:63], v9 offset:4096
  s_waitcnt lgkmcnt(6)
  v_mfma_f32_16x16x32_bf16 v[180:183], v[32:35], v[80:83], v[224:227]
  v_exp_f32 v244, v196
  v_or_b32 v252, v216, v217
  ds_read_b64_tr_b16 v[64:65], v10 offset:0
  v_mfma_f32_16x16x32_bf16 v[188:191], v[32:35], v[96:99], v[228:231]
  ds_read_b64_tr_b16 v[66:67], v10 offset:4096
  v_mfma_f32_16x16x32_bf16 v[180:183], v[36:39], v[84:87], v[180:183]
  v_exp_f32 v245, v197
  ds_read_b64_tr_b16 v[68:69], v11 offset:0
  v_mfma_f32_16x16x32_bf16 v[188:191], v[36:39], v[100:103], v[188:191]
  v_cvt_pk_bf16_f32 v218, v244, v245
  ds_read_b64_tr_b16 v[70:71], v11 offset:4096
  v_mfma_f32_16x16x32_bf16 v[180:183], v[40:43], v[88:91], v[180:183]
  v_exp_f32 v14, v198
  ds_read_b64_tr_b16 v[72:73], v12 offset:0
  v_mfma_f32_16x16x32_bf16 v[188:191], v[40:43], v[104:107], v[188:191]
  ds_read_b64_tr_b16 v[74:75], v12 offset:4096
  v_mfma_f32_16x16x32_bf16 v[180:183], v[44:47], v[92:95], v[180:183]
  v_exp_f32 v15, v199
  ds_read_b64_tr_b16 v[76:77], v13 offset:0
  v_mfma_f32_16x16x32_bf16 v[188:191], v[44:47], v[108:111], v[188:191]
  v_cvt_pk_bf16_f32 v219, v14, v15
  ds_read_b64_tr_b16 v[78:79], v13 offset:4096
  s_waitcnt lgkmcnt(8)
  v_mfma_f32_16x16x32_bf16 v[112:115], v[48:51], v[208:211], v[112:115]
  v_exp_f32 v248, v200
  v_or3_b32 v252, v218, v219, v252
  v_mfma_f32_16x16x32_bf16 v[144:147], v[48:51], v[212:215], v[144:147]
  v_exp_f32 v249, v201
  ds_read_b128 v[16:19], v2 offset:8192
  v_mfma_f32_16x16x32_bf16 v[116:119], v[52:55], v[208:211], v[116:119]
  v_mfma_f32_16x16x32_bf16 v[232:235], v[240:243], v[208:211], v[232:235]
  v_cvt_pk_bf16_f32 v220, v248, v249
  v_mfma_f32_16x16x32_bf16 v[148:151], v[52:55], v[212:215], v[148:151]
  v_exp_f32 v244, v202
  ds_read_b128 v[20:23], v3 offset:8192
  v_mfma_f32_16x16x32_bf16 v[120:123], v[56:59], v[208:211], v[120:123]
  v_mfma_f32_16x16x32_bf16 v[152:155], v[56:59], v[212:215], v[152:155]
  v_exp_f32 v245, v203
  ds_read_b128 v[24:27], v4 offset:8192
  v_mfma_f32_16x16x32_bf16 v[124:127], v[60:63], v[208:211], v[124:127]
  v_cvt_pk_bf16_f32 v221, v244, v245
  v_mfma_f32_16x16x32_bf16 v[156:159], v[60:63], v[212:215], v[156:159]
  v_exp_f32 v14, v204
  v_or3_b32 v252, v220, v221, v252
  ds_read_b128 v[28:31], v5 offset:8192
  s_waitcnt lgkmcnt(4)
  v_mfma_f32_16x16x32_bf16 v[128:131], v[64:67], v[208:211], v[128:131]
  v_mfma_f32_16x16x32_bf16 v[160:163], v[64:67], v[212:215], v[160:163]
  v_exp_f32 v15, v205
  ds_read_b128 v[32:35], v2 offset:12288
  v_mfma_f32_16x16x32_bf16 v[132:135], v[68:71], v[208:211], v[132:135]
  v_mfma_f32_16x16x32_bf16 v[236:239], v[240:243], v[212:215], v[236:239]
  v_cvt_pk_bf16_f32 v222, v14, v15
  v_exp_f32 v248, v206
  v_mfma_f32_16x16x32_bf16 v[164:167], v[68:71], v[212:215], v[164:167]
  v_exp_f32 v249, v207
  ds_read_b128 v[36:39], v3 offset:12288
  v_mfma_f32_16x16x32_bf16 v[136:139], v[72:75], v[208:211], v[136:139]
  v_cvt_pk_bf16_f32 v223, v248, v249
  v_mfma_f32_16x16x32_bf16 v[168:171], v[72:75], v[212:215], v[168:171]
  v_or3_b32 v252, v222, v223, v252
  ds_read_b128 v[40:43], v4 offset:12288
  v_mfma_f32_16x16x32_bf16 v[140:143], v[76:79], v[208:211], v[140:143]
  v_and_b32 v252, 0x40004000, v252
  v_mfma_f32_16x16x32_bf16 v[172:175], v[76:79], v[212:215], v[172:175]
  v_cmp_ne_u32 vcc, 0, v252
  ds_read_b128 v[44:47], v5 offset:12288
  s_cbranch_vccnz RS_23
RB_24:
  s_waitcnt lgkmcnt(4)
  v_mfma_f32_16x16x32_bf16 v[192:195], v[16:19], v[80:83], v[224:227]
  ds_read_b64_tr_b16 v[48:49], v6 offset:8192
  v_exp_f32 v14, v176
  v_mfma_f32_16x16x32_bf16 v[200:203], v[16:19], v[96:99], v[228:231]
  ds_read_b64_tr_b16 v[50:51], v6 offset:12288
  v_mfma_f32_16x16x32_bf16 v[192:195], v[20:23], v[84:87], v[192:195]
  ds_read_b64_tr_b16 v[52:53], v7 offset:8192
  v_exp_f32 v15, v177
  v_mfma_f32_16x16x32_bf16 v[200:203], v[20:23], v[100:103], v[200:203]
  ds_read_b64_tr_b16 v[54:55], v7 offset:12288
  v_cvt_pk_bf16_f32 v208, v14, v15
  v_mfma_f32_16x16x32_bf16 v[192:195], v[24:27], v[88:91], v[192:195]
  ds_read_b64_tr_b16 v[56:57], v8 offset:8192
  v_exp_f32 v248, v178
  v_mfma_f32_16x16x32_bf16 v[200:203], v[24:27], v[104:107], v[200:203]
  ds_read_b64_tr_b16 v[58:59], v8 offset:12288
  v_mfma_f32_16x16x32_bf16 v[192:195], v[28:31], v[92:95], v[192:195]
  ds_read_b64_tr_b16 v[60:61], v9 offset:8192
  v_exp_f32 v249, v179
  v_mfma_f32_16x16x32_bf16 v[200:203], v[28:31], v[108:111], v[200:203]
  ds_read_b64_tr_b16 v[62:63], v9 offset:12288
  v_cvt_pk_bf16_f32 v209, v248, v249
  s_waitcnt lgkmcnt(6)
  v_mfma_f32_16x16x32_bf16 v[196:199], v[32:35], v[80:83], v[224:227]
  ds_read_b64_tr_b16 v[64:65], v10 offset:8192
  v_exp_f32 v244, v180
  v_or_b32 v252, v208, v209
  v_mfma_f32_16x16x32_bf16 v[204:207], v[32:35], v[96:99], v[228:231]
  ds_read_b64_tr_b16 v[66:67], v10 offset:12288
  v_mfma_f32_16x16x32_bf16 v[196:199], v[36:39], v[84:87], v[196:199]
  ds_read_b64_tr_b16 v[68:69], v11 offset:8192
  v_exp_f32 v245, v181
  v_mfma_f32_16x16x32_bf16 v[204:207], v[36:39], v[100:103], v[204:207]
  ds_read_b64_tr_b16 v[70:71], v11 offset:12288
  v_cvt_pk_bf16_f32 v210, v244, v245
  v_mfma_f32_16x16x32_bf16 v[196:199], v[40:43], v[88:91], v[196:199]
  ds_read_b64_tr_b16 v[72:73], v12 offset:8192
  v_exp_f32 v14, v182
  v_mfma_f32_16x16x32_bf16 v[204:207], v[40:43], v[104:107], v[204:207]
  ds_read_b64_tr_b16 v[74:75], v12 offset:12288
  v_mfma_f32_16x16x32_bf16 v[196:199], v[44:47], v[92:95], v[196:199]
  ds_read_b64_tr_b16 v[76:77], v13 offset:8192
  v_exp_f32 v15, v183
  v_mfma_f32_16x16x32_bf16 v[204:207], v[44:47], v[108:111], v[204:207]
  ds_read_b64_tr_b16 v[78:79], v13 offset:12288
  v_cvt_pk_bf16_f32 v211, v14, v15
  s_waitcnt lgkmcnt(8)
  v_mfma_f32_16x16x32_bf16 v[112:115], v[48:51], v[216:219], v[112:115]
  s_barrier
  v_exp_f32 v248, v184
  v_or3_b32 v252, v210, v211, v252
  v_mfma_f32_16x16x32_bf16 v[144:147], v[48:51], v[220:223], v[144:147]
  ds_read_b128 v[16:19], v2 offset:32768
  v_exp_f32 v249, v185
  v_mfma_f32_16x16x32_bf16 v[116:119], v[52:55], v[216:219], v[116:119]
  v_mfma_f32_16x16x32_bf16 v[232:235], v[240:243], v[216:219], v[232:235]
  v_cvt_pk_bf16_f32 v212, v248, v249
  v_mfma_f32_16x16x32_bf16 v[148:151], v[52:55], v[220:223], v[148:151]
  ds_read_b128 v[20:23], v3 offset:32768
  v_exp_f32 v244, v186
  v_mfma_f32_16x16x32_bf16 v[120:123], v[56:59], v[216:219], v[120:123]
  v_mfma_f32_16x16x32_bf16 v[152:155], v[56:59], v[220:223], v[152:155]
  ds_read_b128 v[24:27], v4 offset:32768
  v_exp_f32 v245, v187
  v_mfma_f32_16x16x32_bf16 v[124:127], v[60:63], v[216:219], v[124:127]
  v_cvt_pk_bf16_f32 v213, v244, v245
  v_mfma_f32_16x16x32_bf16 v[156:159], v[60:63], v[220:223], v[156:159]
  ds_read_b128 v[28:31], v5 offset:32768
  v_exp_f32 v14, v188
  v_or3_b32 v252, v212, v213, v252
  s_waitcnt lgkmcnt(4)
  v_mfma_f32_16x16x32_bf16 v[128:131], v[64:67], v[216:219], v[128:131]
  v_mfma_f32_16x16x32_bf16 v[160:163], v[64:67], v[220:223], v[160:163]
  ds_read_b128 v[32:35], v2 offset:36864
  v_exp_f32 v15, v189
  v_mfma_f32_16x16x32_bf16 v[132:135], v[68:71], v[216:219], v[132:135]
  v_mfma_f32_16x16x32_bf16 v[236:239], v[240:243], v[220:223], v[236:239]
  v_cvt_pk_bf16_f32 v214, v14, v15
  v_exp_f32 v248, v190
  v_mfma_f32_16x16x32_bf16 v[164:167], v[68:71], v[220:223], v[164:167]
  ds_read_b128 v[36:39], v3 offset:36864
  v_exp_f32 v249, v191
  v_mfma_f32_16x16x32_bf16 v[136:139], v[72:75], v[216:219], v[136:139]
  v_cvt_pk_bf16_f32 v215, v248, v249
  v_mfma_f32_16x16x32_bf16 v[168:171], v[72:75], v[220:223], v[168:171]
  ds_read_b128 v[40:43], v4 offset:36864
  v_or3_b32 v252, v214, v215, v252
  v_mfma_f32_16x16x32_bf16 v[140:143], v[76:79], v[216:219], v[140:143]
  v_and_b32 v252, 0x40004000, v252
  v_mfma_f32_16x16x32_bf16 v[172:175], v[76:79], v[220:223], v[172:175]
  ds_read_b128 v[44:47], v5 offset:36864
  v_cmp_ne_u32 vcc, 0, v252
  s_cbranch_vccnz RS_25
RB_26:
  s_mov_b32 s9, 0xfffe0000
  v_add_u32 v6, s9, v6
  v_add_u32 v7, s9, v7
  v_add_u32 v8, s9, v8
  v_add_u32 v9, s9, v9
  v_add_u32 v10, s9, v10
  v_add_u32 v11, s9, v11
  v_add_u32 v12, s9, v12
  v_add_u32 v13, s9, v13
  s_waitcnt lgkmcnt(4)
  v_mfma_f32_16x16x32_bf16 v[176:179], v[16:19], v[80:83], v[224:227]
  v_exp_f32 v14, v192
  ds_read_b64_tr_b16 v[48:49], v6 offset:0
  v_mfma_f32_16x16x32_bf16 v[184:187], v[16:19], v[96:99], v[228:231]
  ds_read_b64_tr_b16 v[50:51], v6 offset:4096
  v_mfma_f32_16x16x32_bf16 v[176:179], v[20:23], v[84:87], v[176:179]
  v_exp_f32 v15, v193
  ds_read_b64_tr_b16 v[52:53], v7 offset:0
  v_mfma_f32_16x16x32_bf16 v[184:187], v[20:23], v[100:103], v[184:187]
  v_cvt_pk_bf16_f32 v216, v14, v15
  ds_read_b64_tr_b16 v[54:55], v7 offset:4096
  v_mfma_f32_16x16x32_bf16 v[176:179], v[24:27], v[88:91], v[176:179]
  v_exp_f32 v248, v194
  ds_read_b64_tr_b16 v[56:57], v8 offset:0
  v_mfma_f32_16x16x32_bf16 v[184:187], v[24:27], v[104:107], v[184:187]
  ds_read_b64_tr_b16 v[58:59], v8 offset:4096
  v_mfma_f32_16x16x32_bf16 v[176:179], v[28:31], v[92:95], v[176:179]
  v_exp_f32 v249, v195
  ds_read_b64_tr_b16 v[60:61], v9 offset:0
  v_mfma_f32_16x16x32_bf16 v[184:187], v[28:31], v[108:111], v[184:187]
  v_cvt_pk_bf16_f32 v217, v248, v249
  ds_read_b64_tr_b16 v[62:63], v9 offset:4096
  s_waitcnt lgkmcnt(6)
  v_mfma_f32_16x16x32_bf16 v[180:183], v[32:35], v[80:83], v[224:227]
  v_exp_f32 v244, v196
  v_or_b32 v252, v216, v217
  ds_read_b64_tr_b16 v[64:65], v10 offset:0
  v_mfma_f32_16x16x32_bf16 v[188:191], v[32:35], v[96:99], v[228:231]
  ds_read_b64_tr_b16 v[66:67], v10 offset:4096
  v_mfma_f32_16x16x32_bf16 v[180:183], v[36:39], v[84:87], v[180:183]
  v_exp_f32 v245, v197
  ds_read_b64_tr_b16 v[68:69], v11 offset:0
  v_mfma_f32_16x16x32_bf16 v[188:191], v[36:39], v[100:103], v[188:191]
  v_cvt_pk_bf16_f32 v218, v244, v245
  ds_read_b64_tr_b16 v[70:71], v11 offset:4096
  v_mfma_f32_16x16x32_bf16 v[180:183], v[40:43], v[88:91], v[180:183]
  v_exp_f32 v14, v198
  ds_read_b64_tr_b16 v[72:73], v12 offset:0
  v_mfma_f32_16x16x32_bf16 v[188:191], v[40:43], v[104:107], v[188:191]
  ds_read_b64_tr_b16 v[74:75], v12 offset:4096
  v_mfma_f32_16x16x32_bf16 v[180:183], v[44:47], v[92:95], v[180:183]
  v_exp_f32 v15, v199
  ds_read_b64_tr_b16 v[76:77], v13 offset:0
  v_mfma_f32_16x16x32_bf16 v[188:191], v[44:47], v[108:111], v[188:191]
  v_cvt_pk_bf16_f32 v219, v14, v15
  ds_read_b64_tr_b16 v[78:79], v13 offset:4096
  s_waitcnt lgkmcnt(8)
  v_mfma_f32_16x16x32_bf16 v[112:115], v[48:51], v[208:211], v[112:115]
  v_exp_f32 v248, v200
  v_or3_b32 v252, v218, v219, v252
  v_mfma_f32_16x16x32_bf16 v[144:147], v[48:51], v[212:215], v[144:147]
  v_exp_f32 v249, v201
  ds_read_b128 v[16:19], v2 offset:40960
  v_mfma_f32_16x16x32_bf16 v[116:119], v[52:55], v[208:211], v[116:119]
  v_mfma_f32_16x16x32_bf16 v[232:235], v[240:243], v[208:211], v[232:235]
  v_cvt_pk_bf16_f32 v220, v248, v249
  v_mfma_f32_16x16x32_bf16 v[148:151], v[52:55], v[212:215], v[148:151]
  v_exp_f32 v244, v202
  ds_read_b128 v[20:23], v3 offset:40960
  v_mfma_f32_16x16x32_bf16 v[120:123], v[56:59], v[208:211], v[120:123]
  v_mfma_f32_16x16x32_bf16 v[152:155], v[56:59], v[212:215], v[152:155]
  v_exp_f32 v245, v203
  ds_read_b128 v[24:27], v4 offset:40960
  v_mfma_f32_16x16x32_bf16 v[124:127], v[60:63], v[208:211], v[124:127]
  v_cvt_pk_bf16_f32 v221, v244, v245
  v_mfma_f32_16x16x32_bf16 v[156:159], v[60:63], v[212:215], v[156:159]
  v_exp_f32 v14, v204
  v_or3_b32 v252, v220, v221, v252
  ds_read_b128 v[28:31], v5 offset:40960
  s_waitcnt lgkmcnt(4)
  v_mfma_f32_16x16x32_bf16 v[128:131], v[64:67], v[208:211], v[128:131]
  v_mfma_f32_16x16x32_bf16 v[160:163], v[64:67], v[212:215], v[160:163]
  v_exp_f32 v15, v205
  ds_read_b128 v[32:35], v2 offset:45056
  v_mfma_f32_16x16x32_bf16 v[132:135], v[68:71], v[208:211], v[132:135]
  v_mfma_f32_16x16x32_bf16 v[236:239], v[240:243], v[212:215], v[236:239]
  v_cvt_pk_bf16_f32 v222, v14, v15
  v_exp_f32 v248, v206
  v_mfma_f32_16x16x32_bf16 v[164:167], v[68:71], v[212:215], v[164:167]
  v_exp_f32 v249, v207
  ds_read_b128 v[36:39], v3 offset:45056
  v_mfma_f32_16x16x32_bf16 v[136:139], v[72:75], v[208:211], v[136:139]
  v_cvt_pk_bf16_f32 v223, v248, v249
  v_mfma_f32_16x16x32_bf16 v[168:171], v[72:75], v[212:215], v[168:171]
  v_or3_b32 v252, v222, v223, v252
  ds_read_b128 v[40:43], v4 offset:45056
  v_mfma_f32_16x16x32_bf16 v[140:143], v[76:79], v[208:211], v[140:143]
  v_and_b32 v252, 0x40004000, v252
  v_mfma_f32_16x16x32_bf16 v[172:175], v[76:79], v[212:215], v[172:175]
  v_cmp_ne_u32 vcc, 0, v252
  ds_read_b128 v[44:47], v5 offset:45056
  s_cbranch_vccnz RS_27
RB_28:
  s_waitcnt lgkmcnt(4)
  v_mfma_f32_16x16x32_bf16 v[192:195], v[16:19], v[80:83], v[224:227]
  ds_read_b64_tr_b16 v[48:49], v6 offset:8192
  v_exp_f32 v14, v176
  v_mfma_f32_16x16x32_bf16 v[200:203], v[16:19], v[96:99], v[228:231]
  ds_read_b64_tr_b16 v[50:51], v6 offset:12288
  v_mfma_f32_16x16x32_bf16 v[192:195], v[20:23], v[84:87], v[192:195]
  ds_read_b64_tr_b16 v[52:53], v7 offset:8192
  v_exp_f32 v15, v177
  v_mfma_f32_16x16x32_bf16 v[200:203], v[20:23], v[100:103], v[200:203]
  ds_read_b64_tr_b16 v[54:55], v7 offset:12288
  v_cvt_pk_bf16_f32 v208, v14, v15
  v_mfma_f32_16x16x32_bf16 v[192:195], v[24:27], v[88:91], v[192:195]
  ds_read_b64_tr_b16 v[56:57], v8 offset:8192
  v_exp_f32 v248, v178
  v_mfma_f32_16x16x32_bf16 v[200:203], v[24:27], v[104:107], v[200:203]
  ds_read_b64_tr_b16 v[58:59], v8 offset:12288
  v_mfma_f32_16x16x32_bf16 v[192:195], v[28:31], v[92:95], v[192:195]
  ds_read_b64_tr_b16 v[60:61], v9 offset:8192
  v_exp_f32 v249, v179
  v_mfma_f32_16x16x32_bf16 v[200:203], v[28:31], v[108:111], v[200:203]
  ds_read_b64_tr_b16 v[62:63], v9 offset:12288
  v_cvt_pk_bf16_f32 v209, v248, v249
  s_waitcnt lgkmcnt(6)
  v_mfma_f32_16x16x32_bf16 v[196:199], v[32:35], v[80:83], v[224:227]
  ds_read_b64_tr_b16 v[64:65], v10 offset:8192
  v_exp_f32 v244, v180
  v_or_b32 v252, v208, v209
  v_mfma_f32_16x16x32_bf16 v[204:207], v[32:35], v[96:99], v[228:231]
  ds_read_b64_tr_b16 v[66:67], v10 offset:12288
  v_mfma_f32_16x16x32_bf16 v[196:199], v[36:39], v[84:87], v[196:199]
  ds_read_b64_tr_b16 v[68:69], v11 offset:8192
  v_exp_f32 v245, v181
  v_mfma_f32_16x16x32_bf16 v[204:207], v[36:39], v[100:103], v[204:207]
  ds_read_b64_tr_b16 v[70:71], v11 offset:12288
  v_cvt_pk_bf16_f32 v210, v244, v245
  v_mfma_f32_16x16x32_bf16 v[196:199], v[40:43], v[88:91], v[196:199]
  ds_read_b64_tr_b16 v[72:73], v12 offset:8192
  v_exp_f32 v14, v182
  v_mfma_f32_16x16x32_bf16 v[204:207], v[40:43], v[104:107], v[204:207]
  ds_read_b64_tr_b16 v[74:75], v12 offset:12288
  v_mfma_f32_16x16x32_bf16 v[196:199], v[44:47], v[92:95], v[196:199]
  ds_read_b64_tr_b16 v[76:77], v13 offset:8192
  v_exp_f32 v15, v183
  v_mfma_f32_16x16x32_bf16 v[204:207], v[44:47], v[108:111], v[204:207]
  ds_read_b64_tr_b16 v[78:79], v13 offset:12288
  v_cvt_pk_bf16_f32 v211, v14, v15
  s_waitcnt lgkmcnt(8)
  v_mfma_f32_16x16x32_bf16 v[112:115], v[48:51], v[216:219], v[112:115]
  s_barrier
  s_mov_b32 s8, 0x10000
  v_add_u32 v2, s8, v2
  v_add_u32 v3, s8, v3
  v_add_u32 v4, s8, v4
  v_add_u32 v5, s8, v5
  v_exp_f32 v248, v184
  v_or3_b32 v252, v210, v211, v252
  v_mfma_f32_16x16x32_bf16 v[144:147], v[48:51], v[220:223], v[144:147]
  ds_read_b128 v[16:19], v2 offset:0
  v_exp_f32 v249, v185
  v_mfma_f32_16x16x32_bf16 v[116:119], v[52:55], v[216:219], v[116:119]
  v_mfma_f32_16x16x32_bf16 v[232:235], v[240:243], v[216:219], v[232:235]
  v_cvt_pk_bf16_f32 v212, v248, v249
  v_mfma_f32_16x16x32_bf16 v[148:151], v[52:55], v[220:223], v[148:151]
  ds_read_b128 v[20:23], v3 offset:0
  v_exp_f32 v244, v186
  v_mfma_f32_16x16x32_bf16 v[120:123], v[56:59], v[216:219], v[120:123]
  v_mfma_f32_16x16x32_bf16 v[152:155], v[56:59], v[220:223], v[152:155]
  ds_read_b128 v[24:27], v4 offset:0
  v_exp_f32 v245, v187
  v_mfma_f32_16x16x32_bf16 v[124:127], v[60:63], v[216:219], v[124:127]
  v_cvt_pk_bf16_f32 v213, v244, v245
  v_mfma_f32_16x16x32_bf16 v[156:159], v[60:63], v[220:223], v[156:159]
  ds_read_b128 v[28:31], v5 offset:0
  v_exp_f32 v14, v188
  v_or3_b32 v252, v212, v213, v252
  s_waitcnt lgkmcnt(4)
  v_mfma_f32_16x16x32_bf16 v[128:131], v[64:67], v[216:219], v[128:131]
  v_mfma_f32_16x16x32_bf16 v[160:163], v[64:67], v[220:223], v[160:163]
  ds_read_b128 v[32:35], v2 offset:4096
  v_exp_f32 v15, v189
  v_mfma_f32_16x16x32_bf16 v[132:135], v[68:71], v[216:219], v[132:135]
  v_mfma_f32_16x16x32_bf16 v[236:239], v[240:243], v[220:223], v[236:239]
  v_cvt_pk_bf16_f32 v214, v14, v15
  v_exp_f32 v248, v190
  v_mfma_f32_16x16x32_bf16 v[164:167], v[68:71], v[220:223], v[164:167]
  ds_read_b128 v[36:39], v3 offset:4096
  v_exp_f32 v249, v191
  v_mfma_f32_16x16x32_bf16 v[136:139], v[72:75], v[216:219], v[136:139]
  v_cvt_pk_bf16_f32 v215, v248, v249
  v_mfma_f32_16x16x32_bf16 v[168:171], v[72:75], v[220:223], v[168:171]
  ds_read_b128 v[40:43], v4 offset:4096
  v_or3_b32 v252, v214, v215, v252
  v_mfma_f32_16x16x32_bf16 v[140:143], v[76:79], v[216:219], v[140:143]
  v_and_b32 v252, 0x40004000, v252
  v_mfma_f32_16x16x32_bf16 v[172:175], v[76:79], v[220:223], v[172:175]
  ds_read_b128 v[44:47], v5 offset:4096
  v_cmp_ne_u32 vcc, 0, v252
  s_cbranch_vccnz RS_29
RB_30:
  s_waitcnt lgkmcnt(4)
  v_mfma_f32_16x16x32_bf16 v[176:179], v[16:19], v[80:83], v[224:227]
  v_exp_f32 v14, v192
  ds_read_b64_tr_b16 v[48:49], v6 offset:32768
  v_mfma_f32_16x16x32_bf16 v[184:187], v[16:19], v[96:99], v[228:231]
  ds_read_b64_tr_b16 v[50:51], v6 offset:36864
  v_mfma_f32_16x16x32_bf16 v[176:179], v[20:23], v[84:87], v[176:179]
  v_exp_f32 v15, v193
  ds_read_b64_tr_b16 v[52:53], v7 offset:32768
  v_mfma_f32_16x16x32_bf16 v[184:187], v[20:23], v[100:103], v[184:187]
  v_cvt_pk_bf16_f32 v216, v14, v15
  ds_read_b64_tr_b16 v[54:55], v7 offset:36864
  v_mfma_f32_16x16x32_bf16 v[176:179], v[24:27], v[88:91], v[176:179]
  v_exp_f32 v248, v194
  ds_read_b64_tr_b16 v[56:57], v8 offset:32768
  v_mfma_f32_16x16x32_bf16 v[184:187], v[24:27], v[104:107], v[184:187]
  ds_read_b64_tr_b16 v[58:59], v8 offset:36864
  v_mfma_f32_16x16x32_bf16 v[176:179], v[28:31], v[92:95], v[176:179]
  v_exp_f32 v249, v195
  ds_read_b64_tr_b16 v[60:61], v9 offset:32768
  v_mfma_f32_16x16x32_bf16 v[184:187], v[28:31], v[108:111], v[184:187]
  v_cvt_pk_bf16_f32 v217, v248, v249
  ds_read_b64_tr_b16 v[62:63], v9 offset:36864
  s_waitcnt lgkmcnt(6)
  v_mfma_f32_16x16x32_bf16 v[180:183], v[32:35], v[80:83], v[224:227]
  v_exp_f32 v244, v196
  v_or_b32 v252, v216, v217
  ds_read_b64_tr_b16 v[64:65], v10 offset:32768
  v_mfma_f32_16x16x32_bf16 v[188:191], v[32:35], v[96:99], v[228:231]
  ds_read_b64_tr_b16 v[66:67], v10 offset:36864
  v_mfma_f32_16x16x32_bf16 v[180:183], v[36:39], v[84:87], v[180:183]
  v_exp_f32 v245, v197
  ds_read_b64_tr_b16 v[68:69], v11 offset:32768
  v_mfma_f32_16x16x32_bf16 v[188:191], v[36:39], v[100:103], v[188:191]
  v_cvt_pk_bf16_f32 v218, v244, v245
  ds_read_b64_tr_b16 v[70:71], v11 offset:36864
  v_mfma_f32_16x16x32_bf16 v[180:183], v[40:43], v[88:91], v[180:183]
  v_exp_f32 v14, v198
  ds_read_b64_tr_b16 v[72:73], v12 offset:32768
  v_mfma_f32_16x16x32_bf16 v[188:191], v[40:43], v[104:107], v[188:191]
  ds_read_b64_tr_b16 v[74:75], v12 offset:36864
  v_mfma_f32_16x16x32_bf16 v[180:183], v[44:47], v[92:95], v[180:183]
  v_exp_f32 v15, v199
  ds_read_b64_tr_b16 v[76:77], v13 offset:32768
  v_mfma_f32_16x16x32_bf16 v[188:191], v[44:47], v[108:111], v[188:191]
  v_cvt_pk_bf16_f32 v219, v14, v15
  ds_read_b64_tr_b16 v[78:79], v13 offset:36864
  s_waitcnt lgkmcnt(8)
  v_mfma_f32_16x16x32_bf16 v[112:115], v[48:51], v[208:211], v[112:115]
  v_exp_f32 v248, v200
  v_or3_b32 v252, v218, v219, v252
  v_mfma_f32_16x16x32_bf16 v[144:147], v[48:51], v[212:215], v[144:147]
  v_exp_f32 v249, v201
  ds_read_b128 v[16:19], v2 offset:8192
  v_mfma_f32_16x16x32_bf16 v[116:119], v[52:55], v[208:211], v[116:119]
  v_mfma_f32_16x16x32_bf16 v[232:235], v[240:243], v[208:211], v[232:235]
  v_cvt_pk_bf16_f32 v220, v248, v249
  v_mfma_f32_16x16x32_bf16 v[148:151], v[52:55], v[212:215], v[148:151]
  v_exp_f32 v244, v202
  ds_read_b128 v[20:23], v3 offset:8192
  v_mfma_f32_16x16x32_bf16 v[120:123], v[56:59], v[208:211], v[120:123]
  v_mfma_f32_16x16x32_bf16 v[152:155], v[56:59], v[212:215], v[152:155]
  v_exp_f32 v245, v203
  ds_read_b128 v[24:27], v4 offset:8192
  v_mfma_f32_16x16x32_bf16 v[124:127], v[60:63], v[208:211], v[124:127]
  v_cvt_pk_bf16_f32 v221, v244, v245
  v_mfma_f32_16x16x32_bf16 v[156:159], v[60:63], v[212:215], v[156:159]
  v_exp_f32 v14, v204
  v_or3_b32 v252, v220, v221, v252
  ds_read_b128 v[28:31], v5 offset:8192
  s_waitcnt lgkmcnt(4)
  v_mfma_f32_16x16x32_bf16 v[128:131], v[64:67], v[208:211], v[128:131]
  v_mfma_f32_16x16x32_bf16 v[160:163], v[64:67], v[212:215], v[160:163]
  v_exp_f32 v15, v205
  ds_read_b128 v[32:35], v2 offset:12288
  v_mfma_f32_16x16x32_bf16 v[132:135], v[68:71], v[208:211], v[132:135]
  v_mfma_f32_16x16x32_bf16 v[236:239], v[240:243], v[212:215], v[236:239]
  v_cvt_pk_bf16_f32 v222, v14, v15
  v_exp_f32 v248, v206
  v_mfma_f32_16x16x32_bf16 v[164:167], v[68:71], v[212:215], v[164:167]
  v_exp_f32 v249, v207
  ds_read_b128 v[36:39], v3 offset:12288
  v_mfma_f32_16x16x32_bf16 v[136:139], v[72:75], v[208:211], v[136:139]
  v_cvt_pk_bf16_f32 v223, v248, v249
  v_mfma_f32_16x16x32_bf16 v[168:171], v[72:75], v[212:215], v[168:171]
  v_or3_b32 v252, v222, v223, v252
  ds_read_b128 v[40:43], v4 offset:12288
  v_mfma_f32_16x16x32_bf16 v[140:143], v[76:79], v[208:211], v[140:143]
  v_and_b32 v252, 0x40004000, v252
  v_mfma_f32_16x16x32_bf16 v[172:175], v[76:79], v[212:215], v[172:175]
  v_cmp_ne_u32 vcc, 0, v252
  ds_read_b128 v[44:47], v5 offset:12288
  s_cbranch_vccnz RS_31
RB_32:
  s_waitcnt lgkmcnt(4)
  v_mfma_f32_16x16x32_bf16 v[192:195], v[16:19], v[80:83], v[224:227]
  ds_read_b64_tr_b16 v[48:49], v6 offset:40960
  v_exp_f32 v14, v176
  v_mfma_f32_16x16x32_bf16 v[200:203], v[16:19], v[96:99], v[228:231]
  ds_read_b64_tr_b16 v[50:51], v6 offset:45056
  v_mfma_f32_16x16x32_bf16 v[192:195], v[20:23], v[84:87], v[192:195]
  ds_read_b64_tr_b16 v[52:53], v7 offset:40960
  v_exp_f32 v15, v177
  v_mfma_f32_16x16x32_bf16 v[200:203], v[20:23], v[100:103], v[200:203]
  ds_read_b64_tr_b16 v[54:55], v7 offset:45056
  v_cvt_pk_bf16_f32 v208, v14, v15
  v_mfma_f32_16x16x32_bf16 v[192:195], v[24:27], v[88:91], v[192:195]
  ds_read_b64_tr_b16 v[56:57], v8 offset:40960
  v_exp_f32 v248, v178
  v_mfma_f32_16x16x32_bf16 v[200:203], v[24:27], v[104:107], v[200:203]
  ds_read_b64_tr_b16 v[58:59], v8 offset:45056
  v_mfma_f32_16x16x32_bf16 v[192:195], v[28:31], v[92:95], v[192:195]
  ds_read_b64_tr_b16 v[60:61], v9 offset:40960
  v_exp_f32 v249, v179
  v_mfma_f32_16x16x32_bf16 v[200:203], v[28:31], v[108:111], v[200:203]
  ds_read_b64_tr_b16 v[62:63], v9 offset:45056
  v_cvt_pk_bf16_f32 v209, v248, v249
  s_waitcnt lgkmcnt(6)
  v_mfma_f32_16x16x32_bf16 v[196:199], v[32:35], v[80:83], v[224:227]
  ds_read_b64_tr_b16 v[64:65], v10 offset:40960
  v_exp_f32 v244, v180
  v_or_b32 v252, v208, v209
  v_mfma_f32_16x16x32_bf16 v[204:207], v[32:35], v[96:99], v[228:231]
  ds_read_b64_tr_b16 v[66:67], v10 offset:45056
  v_mfma_f32_16x16x32_bf16 v[196:199], v[36:39], v[84:87], v[196:199]
  ds_read_b64_tr_b16 v[68:69], v11 offset:40960
  v_exp_f32 v245, v181
  v_mfma_f32_16x16x32_bf16 v[204:207], v[36:39], v[100:103], v[204:207]
  ds_read_b64_tr_b16 v[70:71], v11 offset:45056
  v_cvt_pk_bf16_f32 v210, v244, v245
  v_mfma_f32_16x16x32_bf16 v[196:199], v[40:43], v[88:91], v[196:199]
  ds_read_b64_tr_b16 v[72:73], v12 offset:40960
  v_exp_f32 v14, v182
  v_mfma_f32_16x16x32_bf16 v[204:207], v[40:43], v[104:107], v[204:207]
  ds_read_b64_tr_b16 v[74:75], v12 offset:45056
  v_mfma_f32_16x16x32_bf16 v[196:199], v[44:47], v[92:95], v[196:199]
  ds_read_b64_tr_b16 v[76:77], v13 offset:40960
  v_exp_f32 v15, v183
  v_mfma_f32_16x16x32_bf16 v[204:207], v[44:47], v[108:111], v[204:207]
  ds_read_b64_tr_b16 v[78:79], v13 offset:45056
  v_cvt_pk_bf16_f32 v211, v14, v15
  s_waitcnt lgkmcnt(8)
  v_mfma_f32_16x16x32_bf16 v[112:115], v[48:51], v[216:219], v[112:115]
  s_waitcnt lgkmcnt(0)
  s_barrier
  s_mov_b32 s9, 0x10000
  v_add_u32 v6, s9, v6
  v_add_u32 v7, s9, v7
  v_add_u32 v8, s9, v8
  v_add_u32 v9, s9, v9
  v_add_u32 v10, s9, v10
  v_add_u32 v11, s9, v11
  v_add_u32 v12, s9, v12
  v_add_u32 v13, s9, v13
  v_exp_f32 v248, v184
  v_or3_b32 v252, v210, v211, v252
  v_mfma_f32_16x16x32_bf16 v[144:147], v[48:51], v[220:223], v[144:147]
  ds_read_b64_tr_b16 v[48:49], v6 offset:0
  ds_read_b64_tr_b16 v[50:51], v6 offset:4096
  v_exp_f32 v249, v185
  v_mfma_f32_16x16x32_bf16 v[116:119], v[52:55], v[216:219], v[116:119]
  v_mfma_f32_16x16x32_bf16 v[232:235], v[240:243], v[216:219], v[232:235]
  v_cvt_pk_bf16_f32 v212, v248, v249
  v_mfma_f32_16x16x32_bf16 v[148:151], v[52:55], v[220:223], v[148:151]
  ds_read_b64_tr_b16 v[52:53], v7 offset:0
  ds_read_b64_tr_b16 v[54:55], v7 offset:4096
  v_exp_f32 v244, v186
  v_mfma_f32_16x16x32_bf16 v[120:123], v[56:59], v[216:219], v[120:123]
  v_mfma_f32_16x16x32_bf16 v[152:155], v[56:59], v[220:223], v[152:155]
  ds_read_b64_tr_b16 v[56:57], v8 offset:0
  ds_read_b64_tr_b16 v[58:59], v8 offset:4096
  v_exp_f32 v245, v187
  v_mfma_f32_16x16x32_bf16 v[124:127], v[60:63], v[216:219], v[124:127]
  v_cvt_pk_bf16_f32 v213, v244, v245
  v_mfma_f32_16x16x32_bf16 v[156:159], v[60:63], v[220:223], v[156:159]
  ds_read_b64_tr_b16 v[60:61], v9 offset:0
  ds_read_b64_tr_b16 v[62:63], v9 offset:4096
  v_exp_f32 v14, v188
  v_or3_b32 v252, v212, v213, v252
  s_waitcnt lgkmcnt(6)
  v_mfma_f32_16x16x32_bf16 v[128:131], v[64:67], v[216:219], v[128:131]
  v_mfma_f32_16x16x32_bf16 v[160:163], v[64:67], v[220:223], v[160:163]
  ds_read_b64_tr_b16 v[64:65], v10 offset:0
  ds_read_b64_tr_b16 v[66:67], v10 offset:4096
  v_exp_f32 v15, v189
  v_mfma_f32_16x16x32_bf16 v[132:135], v[68:71], v[216:219], v[132:135]
  v_mfma_f32_16x16x32_bf16 v[236:239], v[240:243], v[220:223], v[236:239]
  v_cvt_pk_bf16_f32 v214, v14, v15
  v_exp_f32 v248, v190
  v_mfma_f32_16x16x32_bf16 v[164:167], v[68:71], v[220:223], v[164:167]
  ds_read_b64_tr_b16 v[68:69], v11 offset:0
  ds_read_b64_tr_b16 v[70:71], v11 offset:4096
  v_exp_f32 v249, v191
  v_mfma_f32_16x16x32_bf16 v[136:139], v[72:75], v[216:219], v[136:139]
  v_cvt_pk_bf16_f32 v215, v248, v249
  v_mfma_f32_16x16x32_bf16 v[168:171], v[72:75], v[220:223], v[168:171]
  ds_read_b64_tr_b16 v[72:73], v12 offset:0
  ds_read_b64_tr_b16 v[74:75], v12 offset:4096
  v_or3_b32 v252, v214, v215, v252
  v_mfma_f32_16x16x32_bf16 v[140:143], v[76:79], v[216:219], v[140:143]
  v_and_b32 v252, 0x40004000, v252
  v_mfma_f32_16x16x32_bf16 v[172:175], v[76:79], v[220:223], v[172:175]
  ds_read_b64_tr_b16 v[76:77], v13 offset:0
  ds_read_b64_tr_b16 v[78:79], v13 offset:4096
  v_cmp_ne_u32 vcc, 0, v252
  s_cbranch_vccnz RS_33
RB_34:
  s_waitcnt lgkmcnt(8)
  v_mfma_f32_16x16x32_bf16 v[112:115], v[48:51], v[208:211], v[112:115]
  v_exp_f32 v14, v192
  v_exp_f32 v15, v193
  v_mfma_f32_16x16x32_bf16 v[144:147], v[48:51], v[212:215], v[144:147]
  ds_read_b64_tr_b16 v[48:49], v6 offset:8192
  ds_read_b64_tr_b16 v[50:51], v6 offset:12288
  v_cvt_pk_bf16_f32 v216, v14, v15
  v_exp_f32 v248, v194
  v_mfma_f32_16x16x32_bf16 v[116:119], v[52:55], v[208:211], v[116:119]
  v_mfma_f32_16x16x32_bf16 v[232:235], v[240:243], v[208:211], v[232:235]
  v_exp_f32 v249, v195
  v_mfma_f32_16x16x32_bf16 v[148:151], v[52:55], v[212:215], v[148:151]
  ds_read_b64_tr_b16 v[52:53], v7 offset:8192
  ds_read_b64_tr_b16 v[54:55], v7 offset:12288
  v_cvt_pk_bf16_f32 v217, v248, v249
  v_exp_f32 v244, v196
  v_exp_f32 v245, v197
  v_mfma_f32_16x16x32_bf16 v[120:123], v[56:59], v[208:211], v[120:123]
  v_cvt_pk_bf16_f32 v218, v244, v245
  v_exp_f32 v14, v198
  v_or_b32 v252, v216, v217
  v_mfma_f32_16x16x32_bf16 v[152:155], v[56:59], v[212:215], v[152:155]
  ds_read_b64_tr_b16 v[56:57], v8 offset:8192
  ds_read_b64_tr_b16 v[58:59], v8 offset:12288
  v_exp_f32 v15, v199
  v_mfma_f32_16x16x32_bf16 v[124:127], v[60:63], v[208:211], v[124:127]
  v_cvt_pk_bf16_f32 v219, v14, v15
  v_exp_f32 v248, v200
  v_exp_f32 v249, v201
  v_mfma_f32_16x16x32_bf16 v[156:159], v[60:63], v[212:215], v[156:159]
  ds_read_b64_tr_b16 v[60:61], v9 offset:8192
  ds_read_b64_tr_b16 v[62:63], v9 offset:12288
  v_cvt_pk_bf16_f32 v220, v248, v249
  v_exp_f32 v244, v202
  v_or3_b32 v252, v218, v219, v252
  s_waitcnt lgkmcnt(6)
  v_mfma_f32_16x16x32_bf16 v[128:131], v[64:67], v[208:211], v[128:131]
  v_exp_f32 v245, v203
  v_mfma_f32_16x16x32_bf16 v[160:163], v[64:67], v[212:215], v[160:163]
  ds_read_b64_tr_b16 v[64:65], v10 offset:8192
  ds_read_b64_tr_b16 v[66:67], v10 offset:12288
  v_cvt_pk_bf16_f32 v221, v244, v245
  v_exp_f32 v14, v204
  v_exp_f32 v15, v205
  v_mfma_f32_16x16x32_bf16 v[132:135], v[68:71], v[208:211], v[132:135]
  v_mfma_f32_16x16x32_bf16 v[236:239], v[240:243], v[212:215], v[236:239]
  v_cvt_pk_bf16_f32 v222, v14, v15
  v_exp_f32 v248, v206
  v_or3_b32 v252, v220, v221, v252
  v_mfma_f32_16x16x32_bf16 v[164:167], v[68:71], v[212:215], v[164:167]
  ds_read_b64_tr_b16 v[68:69], v11 offset:8192
  ds_read_b64_tr_b16 v[70:71], v11 offset:12288
  v_exp_f32 v249, v207
  v_mfma_f32_16x16x32_bf16 v[136:139], v[72:75], v[208:211], v[136:139]
  v_cvt_pk_bf16_f32 v223, v248, v249
  v_mfma_f32_16x16x32_bf16 v[168:171], v[72:75], v[212:215], v[168:171]
  ds_read_b64_tr_b16 v[72:73], v12 offset:8192
  ds_read_b64_tr_b16 v[74:75], v12 offset:12288
  v_or3_b32 v252, v222, v223, v252
  v_mfma_f32_16x16x32_bf16 v[140:143], v[76:79], v[208:211], v[140:143]
  v_and_b32 v252, 0x40004000, v252
  v_mfma_f32_16x16x32_bf16 v[172:175], v[76:79], v[212:215], v[172:175]
  ds_read_b64_tr_b16 v[76:77], v13 offset:8192
  ds_read_b64_tr_b16 v[78:79], v13 offset:12288
  v_cmp_ne_u32 vcc, 0, v252
  s_cbranch_vccnz RS_35
RB_36:
  s_waitcnt lgkmcnt(8)
  v_mfma_f32_16x16x32_bf16 v[112:115], v[48:51], v[216:219], v[112:115]
  v_mfma_f32_16x16x32_bf16 v[144:147], v[48:51], v[220:223], v[144:147]
  v_mfma_f32_16x16x32_bf16 v[116:119], v[52:55], v[216:219], v[116:119]
  v_mfma_f32_16x16x32_bf16 v[148:151], v[52:55], v[220:223], v[148:151]
  v_mfma_f32_16x16x32_bf16 v[232:235], v[240:243], v[216:219], v[232:235]
  v_mfma_f32_16x16x32_bf16 v[236:239], v[240:243], v[220:223], v[236:239]
  v_mfma_f32_16x16x32_bf16 v[120:123], v[56:59], v[216:219], v[120:123]
  v_mfma_f32_16x16x32_bf16 v[152:155], v[56:59], v[220:223], v[152:155]
  v_mfma_f32_16x16x32_bf16 v[124:127], v[60:63], v[216:219], v[124:127]
  v_mfma_f32_16x16x32_bf16 v[156:159], v[60:63], v[220:223], v[156:159]
  s_lshl_b32 s64, s75, 17
  s_lshl_b32 s8, s6, 13
  s_add_u32 s64, s64, s8
  s_lshl_b32 s8, s15, 10
  s_add_u32 s64, s64, s8
  s_add_u32 s64, s64, 0x400000
  v_and_b32 v244, 15, v0
  v_bfe_u32 v245, v0, 4, 1
  v_lshl_add_u32 v244, v245, 5, v244
  v_lshlrev_b32 v244, 4, v244
  v_lshrrev_b32 v247, 5, v0
  v_lshl_add_u32 v246, v247, 12, v244
  v_lshl_add_u32 v247, v247, 10, v244
  s_lshl_b32 s11, s6, 11
  s_add_u32 s11, s11, 65536
  v_add_u32 v247, s11, v247
  s_waitcnt lgkmcnt(0)
  v_mfma_f32_16x16x32_bf16 v[128:131], v[64:67], v[216:219], v[128:131]
  v_mfma_f32_16x16x32_bf16 v[160:163], v[64:67], v[220:223], v[160:163]
  v_mfma_f32_16x16x32_bf16 v[132:135], v[68:71], v[216:219], v[132:135]
  v_mfma_f32_16x16x32_bf16 v[164:167], v[68:71], v[220:223], v[164:167]
  v_cvt_pk_bf16_f32 v16, v112, v113
  v_cvt_pk_bf16_f32 v17, v114, v115
  v_cvt_pk_bf16_f32 v18, v116, v117
  v_cvt_pk_bf16_f32 v19, v118, v119
  v_cvt_pk_bf16_f32 v20, v144, v145
  v_cvt_pk_bf16_f32 v21, v146, v147
  v_cvt_pk_bf16_f32 v22, v148, v149
  v_cvt_pk_bf16_f32 v23, v150, v151
  v_mfma_f32_16x16x32_bf16 v[136:139], v[72:75], v[216:219], v[136:139]
  v_mfma_f32_16x16x32_bf16 v[168:171], v[72:75], v[220:223], v[168:171]
  v_mfma_f32_16x16x32_bf16 v[140:143], v[76:79], v[216:219], v[140:143]
  v_mfma_f32_16x16x32_bf16 v[172:175], v[76:79], v[220:223], v[172:175]
  s_cmp_eq_u32 s15, 0
  s_cbranch_scc1 LOC_37
  s_add_u32 s8, s64, 0x0
  buffer_store_dwordx4 v[16:19], v246, s[60:63], s8 offen sc1
  buffer_store_dwordx4 v[20:23], v246, s[60:63], s8 offen offset:256 sc1
  s_branch NXT_38
LOC_37:
  ds_write_b128 v247, v[16:19]
  ds_write_b128 v247, v[20:23] offset:256
NXT_38:
  v_cvt_pk_bf16_f32 v24, v120, v121
  v_cvt_pk_bf16_f32 v25, v122, v123
  v_cvt_pk_bf16_f32 v26, v124, v125
  v_cvt_pk_bf16_f32 v27, v126, v127
  v_cvt_pk_bf16_f32 v28, v152, v153
  v_cvt_pk_bf16_f32 v29, v154, v155
  v_cvt_pk_bf16_f32 v30, v156, v157
  v_cvt_pk_bf16_f32 v31, v158, v159
  s_cmp_eq_u32 s15, 1
  s_cbranch_scc1 LOC_39
  s_add_u32 s8, s64, 0x8000
  buffer_store_dwordx4 v[24:27], v246, s[60:63], s8 offen sc1
  buffer_store_dwordx4 v[28:31], v246, s[60:63], s8 offen offset:256 sc1
  s_branch NXT_40
LOC_39:
  ds_write_b128 v247, v[24:27]
  ds_write_b128 v247, v[28:31] offset:256
NXT_40:
  s_lshl_b32 s9, s75, 2
  s_add_u32 s9, s9, s6
  s_lshl_b32 s10, s9, 10
  s_lshl_b32 s11, s15, 8
  s_add_u32 s10, s10, s11
  s_add_u32 s10, s10, 0xc00000
  v_cmp_ne_u32 vcc, 0, v245
  v_and_b32 v252, 31, v0
  v_lshlrev_b32 v252, 3, v252
  v_cndmask_b32 v14, v224, v228, vcc
  v_cndmask_b32 v15, v232, v236, vcc
  v_sub_f32 v14, 0, v14
  s_lshl_b32 s11, s6, 8
  s_add_u32 s11, s11, 73728
  v_add_u32 v254, s11, v252
  buffer_store_dwordx2 v[14:15], v252, s[60:63], s10 offen sc1
  ds_write_b64 v254, v[14:15]
  s_setprio 0
  v_cvt_pk_bf16_f32 v32, v128, v129
  v_cvt_pk_bf16_f32 v33, v130, v131
  v_cvt_pk_bf16_f32 v34, v132, v133
  v_cvt_pk_bf16_f32 v35, v134, v135
  v_cvt_pk_bf16_f32 v36, v160, v161
  v_cvt_pk_bf16_f32 v37, v162, v163
  v_cvt_pk_bf16_f32 v38, v164, v165
  v_cvt_pk_bf16_f32 v39, v166, v167
  s_cmp_eq_u32 s15, 2
  s_cbranch_scc1 LOC_41
  s_add_u32 s8, s64, 0x10000
  buffer_store_dwordx4 v[32:35], v246, s[60:63], s8 offen sc1
  buffer_store_dwordx4 v[36:39], v246, s[60:63], s8 offen offset:256 sc1
  s_branch NXT_42
LOC_41:
  ds_write_b128 v247, v[32:35]
  ds_write_b128 v247, v[36:39] offset:256
NXT_42:
  v_cvt_pk_bf16_f32 v40, v136, v137
  v_cvt_pk_bf16_f32 v41, v138, v139
  v_cvt_pk_bf16_f32 v42, v140, v141
  v_cvt_pk_bf16_f32 v43, v142, v143
  v_cvt_pk_bf16_f32 v44, v168, v169
  v_cvt_pk_bf16_f32 v45, v170, v171
  v_cvt_pk_bf16_f32 v46, v172, v173
  v_cvt_pk_bf16_f32 v47, v174, v175
  s_cmp_eq_u32 s15, 3
  s_cbranch_scc1 LOC_43
  s_add_u32 s8, s64, 0x18000
  buffer_store_dwordx4 v[40:43], v246, s[60:63], s8 offen sc1
  buffer_store_dwordx4 v[44:47], v246, s[60:63], s8 offen offset:256 sc1
  s_branch NXT_44
LOC_43:
  ds_write_b128 v247, v[40:43]
  ds_write_b128 v247, v[44:47] offset:256
NXT_44:
L_BACK:
  s_and_b32 s66, s5, 1
  s_lshr_b32 s74, s5, 1
  s_sub_u32 s8, s74, s67
  s_and_b32 s8, s8, 3
  s_sub_u32 s10, s8, 2
  s_add_u32 s11, s8, 3
  s_cmp_lt_u32 s8, 2
  s_cselect_b32 s10, s11, s10
  s_lshl_b32 s10, s10, 15
  v_lshrrev_b32 v4, 5, v0
  v_bfe_u32 v5, v0, 2, 2
  v_lshl_add_u32 v6, v4, 2, v5
  v_lshlrev_b32 v6, 7, v6
  v_and_b32 v7, 1, v0
  v_lshl_add_u32 v6, v7, 3, v6
  v_add_u32 v6, s10, v6
  v_bfe_u32 v7, v0, 1, 1
  v_bfe_u32 v8, v0, 4, 1
  v_lshl_add_u32 v7, v8, 1, v7
  v_lshlrev_b32 v5, 1, v5
  v_and_b32 v5, 4, v5
  v_xor_b32 v7, v7, v5
  v_lshl_add_u32 v2, v7, 4, v6
  v_xor_b32 v7, 4, v7
  v_lshl_add_u32 v3, v7, 4, v6
  s_lshl_b32 s9, s75, 2
  s_add_u32 s9, s9, s6
  s_lshl_b32 s65, s9, 10
  s_add_u32 s65, s65, 0xc00000
  s_lshl_b32 s64, s75, 17
  s_lshl_b32 s8, s15, 15
  s_add_u32 s64, s64, s8
  s_lshl_b32 s8, s6, 13
  s_add_u32 s64, s64, s8
  s_lshl_b32 s8, s7, 12
  s_add_u32 s64, s64, s8
  s_add_u32 s64, s64, 0x400000
  v_and_b32 v252, 31, v0
  v_lshlrev_b32 v252, 3, v252
  s_lshl_b32 s8, s6, 11
  s_lshl_b32 s10, s7, 10
  s_add_u32 s8, s8, s10
  s_add_u32 s8, s8, 65536
  v_add_u32 v253, s8, v1
  s_lshl_b32 s8, s6, 8
  s_add_u32 s8, s8, 73728
  v_add_u32 v254, s8, v252
  s_mul_i32 s10, s75, 1152
  s_add_u32 s10, s10, 0x2200000
  s_lshl_b32 s11, s15, 3
  s_add_u32 s11, s11, s10
  s_waitcnt vmcnt(0) lgkmcnt(0)
  s_barrier
  ds_read_b64 v[16:17], v254
  ds_read_b128 v[48:51], v253
  s_cmp_lg_u32 s5, 0
  s_cbranch_scc1 L_NOF2
  v_mov_b32 v255, s11
  s_mov_b64 exec, 1
  buffer_store_dwordx2 v[250:251], v255, s[60:63], 0 offen sc1
  s_mov_b64 exec, -1
  v_and_b32 v244, 3, v0
  v_lshlrev_b32 v244, 3, v244
  s_mov_b32 s12, 0
  s_mov_b64 exec, 15
POLL_45:
  v_mov_b32 v246, 0
  v_mov_b32 v247, 0
  buffer_atomic_or_x2 v[246:247], v244, s[60:63], s10 offen sc0 sc1
  s_add_u32 s12, s12, 1
  s_waitcnt vmcnt(0)
  v_cmp_ne_u64 vcc, s[70:71], v[246:247]
  s_cbranch_vccz POLLD_46
  s_cmp_lt_u32 s12, 0x200000
  s_cbranch_scc1 POLL_45
POLLD_46:
  s_mov_b64 exec, -1
  s_branch L_NOP2
L_NOF2:
  ds_read_b64_tr_b16 v[112:113], v2 offset:0
  ds_read_b64_tr_b16 v[114:115], v2 offset:2048
  ds_read_b64_tr_b16 v[116:117], v3 offset:0
  ds_read_b64_tr_b16 v[118:119], v3 offset:2048
  ds_read_b64_tr_b16 v[120:121], v2 offset:1024
  ds_read_b64_tr_b16 v[122:123], v2 offset:3072
  ds_read_b64_tr_b16 v[124:125], v3 offset:1024
  ds_read_b64_tr_b16 v[126:127], v3 offset:3072
  s_waitcnt lgkmcnt(5)
  ds_read_b64_tr_b16 v[128:129], v2 offset:4096
  ds_read_b64_tr_b16 v[130:131], v2 offset:6144
  ds_read_b64_tr_b16 v[132:133], v3 offset:4096
  ds_read_b64_tr_b16 v[134:135], v3 offset:6144
  ds_read_b64_tr_b16 v[136:137], v2 offset:5120
  ds_read_b64_tr_b16 v[138:139], v2 offset:7168
  ds_read_b64_tr_b16 v[140:141], v3 offset:5120
  ds_read_b64_tr_b16 v[142:143], v3 offset:7168
  s_waitcnt lgkmcnt(5)
  ds_read_b64_tr_b16 v[144:145], v2 offset:8192
  ds_read_b64_tr_b16 v[146:147], v2 offset:10240
  ds_read_b64_tr_b16 v[148:149], v3 offset:8192
  ds_read_b64_tr_b16 v[150:151], v3 offset:10240
  ds_read_b64_tr_b16 v[152:153], v2 offset:9216
  ds_read_b64_tr_b16 v[154:155], v2 offset:11264
  ds_read_b64_tr_b16 v[156:157], v3 offset:9216
  ds_read_b64_tr_b16 v[158:159], v3 offset:11264
  s_waitcnt lgkmcnt(5)
  ds_read_b64_tr_b16 v[160:161], v2 offset:12288
  ds_read_b64_tr_b16 v[162:163], v2 offset:14336
  ds_read_b64_tr_b16 v[164:165], v3 offset:12288
  ds_read_b64_tr_b16 v[166:167], v3 offset:14336
  ds_read_b64_tr_b16 v[168:169], v2 offset:13312
  ds_read_b64_tr_b16 v[170:171], v2 offset:15360
  ds_read_b64_tr_b16 v[172:173], v3 offset:13312
  ds_read_b64_tr_b16 v[174:175], v3 offset:15360
  s_waitcnt lgkmcnt(5)
  ds_read_b64_tr_b16 v[176:177], v2 offset:16384
  ds_read_b64_tr_b16 v[178:179], v2 offset:18432
  ds_read_b64_tr_b16 v[180:181], v3 offset:16384
  ds_read_b64_tr_b16 v[182:183], v3 offset:18432
  ds_read_b64_tr_b16 v[184:185], v2 offset:17408
  ds_read_b64_tr_b16 v[186:187], v2 offset:19456
  ds_read_b64_tr_b16 v[188:189], v3 offset:17408
  ds_read_b64_tr_b16 v[190:191], v3 offset:19456
  s_waitcnt lgkmcnt(5)
  ds_read_b64_tr_b16 v[192:193], v2 offset:20480
  ds_read_b64_tr_b16 v[194:195], v2 offset:22528
  ds_read_b64_tr_b16 v[196:197], v3 offset:20480
  ds_read_b64_tr_b16 v[198:199], v3 offset:22528
  ds_read_b64_tr_b16 v[200:201], v2 offset:21504
  ds_read_b64_tr_b16 v[202:203], v2 offset:23552
  ds_read_b64_tr_b16 v[204:205], v3 offset:21504
  ds_read_b64_tr_b16 v[206:207], v3 offset:23552
  s_waitcnt lgkmcnt(5)
  ds_read_b64_tr_b16 v[208:209], v2 offset:24576
  ds_read_b64_tr_b16 v[210:211], v2 offset:26624
  ds_read_b64_tr_b16 v[212:213], v3 offset:24576
  ds_read_b64_tr_b16 v[214:215], v3 offset:26624
  ds_read_b64_tr_b16 v[216:217], v2 offset:25600
  ds_read_b64_tr_b16 v[218:219], v2 offset:27648
  ds_read_b64_tr_b16 v[220:221], v3 offset:25600
  ds_read_b64_tr_b16 v[222:223], v3 offset:27648
  s_waitcnt lgkmcnt(5)
  ds_read_b64_tr_b16 v[224:225], v2 offset:28672
  ds_read_b64_tr_b16 v[226:227], v2 offset:30720
  ds_read_b64_tr_b16 v[228:229], v3 offset:28672
  ds_read_b64_tr_b16 v[230:231], v3 offset:30720
  ds_read_b64_tr_b16 v[232:233], v2 offset:29696
  ds_read_b64_tr_b16 v[234:235], v2 offset:31744
  ds_read_b64_tr_b16 v[236:237], v3 offset:29696
  ds_read_b64_tr_b16 v[238:239], v3 offset:31744
  s_waitcnt lgkmcnt(5)
  s_waitcnt lgkmcnt(0)
L_NOP2:
  s_barrier
  s_add_u32 s8, s15, 1
  s_and_b32 s8, s8, 3
  s_lshl_b32 s10, s8, 8
  s_add_u32 s10, s10, s65
  buffer_load_dwordx2 v[18:19], v252, s[60:63], s10 offen sc0 sc1
  s_add_u32 s8, s15, 2
  s_and_b32 s8, s8, 3
  s_lshl_b32 s10, s8, 8
  s_add_u32 s10, s10, s65
  buffer_load_dwordx2 v[20:21], v252, s[60:63], s10 offen sc0 sc1
  s_add_u32 s8, s15, 3
  s_and_b32 s8, s8, 3
  s_lshl_b32 s10, s8, 8
  s_add_u32 s10, s10, s65
  buffer_load_dwordx2 v[22:23], v252, s[60:63], s10 offen sc0 sc1
  s_add_u32 s8, s15, 1
  s_and_b32 s8, s8, 3
  s_lshl_b32 s10, s8, 10
  s_add_u32 s10, s10, s64
  buffer_load_dwordx4 v[52:55], v1, s[60:63], s10 offen sc0 sc1
  s_add_u32 s8, s15, 2
  s_and_b32 s8, s8, 3
  s_lshl_b32 s10, s8, 10
  s_add_u32 s10, s10, s64
  buffer_load_dwordx4 v[56:59], v1, s[60:63], s10 offen sc0 sc1
  s_add_u32 s8, s15, 3
  s_and_b32 s8, s8, 3
  s_lshl_b32 s10, s8, 10
  s_add_u32 s10, s10, s64
  buffer_load_dwordx4 v[60:63], v1, s[60:63], s10 offen sc0 sc1
  s_lshl_b32 s8, s9, 13
  s_lshl_b32 s10, s15, 11
  s_add_u32 s8, s8, s10
  s_lshl_b32 s10, s7, 10
  s_add_u32 s8, s8, s10
  s_add_u32 s9, s8, 0x200000
  s_lshl_b32 s8, s67, 1
  s_add_u32 s8, s8, s66
  s_lshl_b32 s8, s8, 2
  s_add_u32 s8, s8, s97
  s_lshl_b32 s64, s8, 16
  s_lshl_b32 s10, s74, 14
  s_add_u32 s64, s64, s10
  s_add_u32 s64, s64, 0x200000
  s_mul_i32 s10, s75, 18432
  s_lshl_b32 s11, s15, 3
  s_add_u32 s10, s10, s11
  s_add_u32 s10, s10, 0x2300000
  v_mul_u32_u24 v255, 1152, v0
  v_add_u32 v255, s10, v255
  s_lshl_b32 s8, s67, 3
  s_add_u32 s8, s8, s97
  s_lshl_b32 s8, s8, 5
  s_add_u32 s8, s8, s96
  s_mul_i32 s65, s8, 1152
  s_add_u32 s65, s65, 0x2300000
  s_cmp_lg_u32 s5, 0
  s_cbranch_scc1 L_NOB
  ds_read_b64_tr_b16 v[112:113], v2 offset:0
  ds_read_b64_tr_b16 v[114:115], v2 offset:2048
  ds_read_b64_tr_b16 v[116:117], v3 offset:0
  ds_read_b64_tr_b16 v[118:119], v3 offset:2048
  ds_read_b64_tr_b16 v[120:121], v2 offset:1024
  ds_read_b64_tr_b16 v[122:123], v2 offset:3072
  ds_read_b64_tr_b16 v[124:125], v3 offset:1024
  ds_read_b64_tr_b16 v[126:127], v3 offset:3072
  s_waitcnt lgkmcnt(5)
  ds_read_b64_tr_b16 v[128:129], v2 offset:4096
  ds_read_b64_tr_b16 v[130:131], v2 offset:6144
  ds_read_b64_tr_b16 v[132:133], v3 offset:4096
  ds_read_b64_tr_b16 v[134:135], v3 offset:6144
  ds_read_b64_tr_b16 v[136:137], v2 offset:5120
  ds_read_b64_tr_b16 v[138:139], v2 offset:7168
  ds_read_b64_tr_b16 v[140:141], v3 offset:5120
  ds_read_b64_tr_b16 v[142:143], v3 offset:7168
  s_waitcnt lgkmcnt(5)
  ds_read_b64_tr_b16 v[144:145], v2 offset:8192
  ds_read_b64_tr_b16 v[146:147], v2 offset:10240
  ds_read_b64_tr_b16 v[148:149], v3 offset:8192
  ds_read_b64_tr_b16 v[150:151], v3 offset:10240
  ds_read_b64_tr_b16 v[152:153], v2 offset:9216
  ds_read_b64_tr_b16 v[154:155], v2 offset:11264
  ds_read_b64_tr_b16 v[156:157], v3 offset:9216
  ds_read_b64_tr_b16 v[158:159], v3 offset:11264
  s_waitcnt lgkmcnt(5)
  ds_read_b64_tr_b16 v[160:161], v2 offset:12288
  ds_read_b64_tr_b16 v[162:163], v2 offset:14336
  ds_read_b64_tr_b16 v[164:165], v3 offset:12288
  ds_read_b64_tr_b16 v[166:167], v3 offset:14336
  ds_read_b64_tr_b16 v[168:169], v2 offset:13312
  ds_read_b64_tr_b16 v[170:171], v2 offset:15360
  ds_read_b64_tr_b16 v[172:173], v3 offset:13312
  ds_read_b64_tr_b16 v[174:175], v3 offset:15360
  s_waitcnt lgkmcnt(5)
  ds_read_b64_tr_b16 v[176:177], v2 offset:16384
  ds_read_b64_tr_b16 v[178:179], v2 offset:18432
  ds_read_b64_tr_b16 v[180:181], v3 offset:16384
  ds_read_b64_tr_b16 v[182:183], v3 offset:18432
  ds_read_b64_tr_b16 v[184:185], v2 offset:17408
  ds_read_b64_tr_b16 v[186:187], v2 offset:19456
  ds_read_b64_tr_b16 v[188:189], v3 offset:17408
  ds_read_b64_tr_b16 v[190:191], v3 offset:19456
  s_waitcnt lgkmcnt(5)
  ds_read_b64_tr_b16 v[192:193], v2 offset:20480
  ds_read_b64_tr_b16 v[194:195], v2 offset:22528
  ds_read_b64_tr_b16 v[196:197], v3 offset:20480
  ds_read_b64_tr_b16 v[198:199], v3 offset:22528
  ds_read_b64_tr_b16 v[200:201], v2 offset:21504
  ds_read_b64_tr_b16 v[202:203], v2 offset:23552
  ds_read_b64_tr_b16 v[204:205], v3 offset:21504
  ds_read_b64_tr_b16 v[206:207], v3 offset:23552
  s_waitcnt lgkmcnt(5)
  ds_read_b64_tr_b16 v[208:209], v2 offset:24576
  ds_read_b64_tr_b16 v[210:211], v2 offset:26624
  ds_read_b64_tr_b16 v[212:213], v3 offset:24576
  ds_read_b64_tr_b16 v[214:215], v3 offset:26624
  ds_read_b64_tr_b16 v[216:217], v2 offset:25600
  ds_read_b64_tr_b16 v[218:219], v2 offset:27648
  ds_read_b64_tr_b16 v[220:221], v3 offset:25600
  ds_read_b64_tr_b16 v[222:223], v3 offset:27648
  s_waitcnt lgkmcnt(5)
  ds_read_b64_tr_b16 v[224:225], v2 offset:28672
  ds_read_b64_tr_b16 v[226:227], v2 offset:30720
  ds_read_b64_tr_b16 v[228:229], v3 offset:28672
  ds_read_b64_tr_b16 v[230:231], v3 offset:30720
  ds_read_b64_tr_b16 v[232:233], v2 offset:29696
  ds_read_b64_tr_b16 v[234:235], v2 offset:31744
  ds_read_b64_tr_b16 v[236:237], v3 offset:29696
  ds_read_b64_tr_b16 v[238:239], v3 offset:31744
  s_waitcnt lgkmcnt(5)
  s_waitcnt lgkmcnt(0)
L_NOB:
  v_lshlrev_b32 v32, 16, v48
  v_and_b32 v33, 0xffff0000, v48
  v_lshlrev_b32 v34, 16, v49
  v_and_b32 v35, 0xffff0000, v49
  v_lshlrev_b32 v36, 16, v50
  v_and_b32 v37, 0xffff0000, v50
  v_lshlrev_b32 v38, 16, v51
  v_and_b32 v39, 0xffff0000, v51
  s_waitcnt vmcnt(3)
  v_max3_f32 v24, v16, v18, v20
  v_max_f32 v24, v22, v24
  v_sub_f32 v16, v16, v24
  v_sub_f32 v18, v18, v24
  v_sub_f32 v20, v20, v24
  v_sub_f32 v22, v22, v24
  v_exp_f32 v16, v16
  v_exp_f32 v18, v18
  v_exp_f32 v20, v20
  v_exp_f32 v22, v22
  s_nop 0
  v_mul_f32 v24, v16, v17
  v_fmac_f32 v24, v18, v19
  v_fmac_f32 v24, v20, v21
  v_fmac_f32 v24, v22, v23
  v_rcp_f32 v24, v24
  s_nop 0
  v_mul_f32 v16, v16, v24
  v_mul_f32 v18, v18, v24
  v_mul_f32 v20, v20, v24
  v_mul_f32 v22, v22, v24
  v_mul_f32 v32, v32, v16
  v_mul_f32 v33, v33, v16
  v_mul_f32 v34, v34, v16
  v_mul_f32 v35, v35, v16
  v_mul_f32 v36, v36, v16
  v_mul_f32 v37, v37, v16
  v_mul_f32 v38, v38, v16
  v_mul_f32 v39, v39, v16
  s_waitcnt vmcnt(2)
  v_lshlrev_b32 v28, 16, v52
  v_and_b32 v29, 0xffff0000, v52
  v_fmac_f32 v32, v28, v18
  v_fmac_f32 v33, v29, v18
  v_lshlrev_b32 v28, 16, v53
  v_and_b32 v29, 0xffff0000, v53
  v_fmac_f32 v34, v28, v18
  v_fmac_f32 v35, v29, v18
  v_lshlrev_b32 v28, 16, v54
  v_and_b32 v29, 0xffff0000, v54
  v_fmac_f32 v36, v28, v18
  v_fmac_f32 v37, v29, v18
  v_lshlrev_b32 v28, 16, v55
  v_and_b32 v29, 0xffff0000, v55
  v_fmac_f32 v38, v28, v18
  v_fmac_f32 v39, v29, v18
  s_waitcnt vmcnt(1)
  v_lshlrev_b32 v28, 16, v56
  v_and_b32 v29, 0xffff0000, v56
  v_fmac_f32 v32, v28, v20
  v_fmac_f32 v33, v29, v20
  v_lshlrev_b32 v28, 16, v57
  v_and_b32 v29, 0xffff0000, v57
  v_fmac_f32 v34, v28, v20
  v_fmac_f32 v35, v29, v20
  v_lshlrev_b32 v28, 16, v58
  v_and_b32 v29, 0xffff0000, v58
  v_fmac_f32 v36, v28, v20
  v_fmac_f32 v37, v29, v20
  v_lshlrev_b32 v28, 16, v59
  v_and_b32 v29, 0xffff0000, v59
  v_fmac_f32 v38, v28, v20
  v_fmac_f32 v39, v29, v20
  s_waitcnt vmcnt(0)
  v_lshlrev_b32 v28, 16, v60
  v_and_b32 v29, 0xffff0000, v60
  v_fmac_f32 v32, v28, v22
  v_fmac_f32 v33, v29, v22
  v_lshlrev_b32 v28, 16, v61
  v_and_b32 v29, 0xffff0000, v61
  v_fmac_f32 v34, v28, v22
  v_fmac_f32 v35, v29, v22
  v_lshlrev_b32 v28, 16, v62
  v_and_b32 v29, 0xffff0000, v62
  v_fmac_f32 v36, v28, v22
  v_fmac_f32 v37, v29, v22
  v_lshlrev_b32 v28, 16, v63
  v_and_b32 v29, 0xffff0000, v63
  v_fmac_f32 v38, v28, v22
  v_fmac_f32 v39, v29, v22
  v_cvt_pk_bf16_f32 v40, v32, v33
  v_cvt_pk_bf16_f32 v41, v34, v35
  v_cvt_pk_bf16_f32 v42, v36, v37
  v_cvt_pk_bf16_f32 v43, v38, v39
  buffer_store_dwordx4 v[40:43], v1, s[60:63], s9 offen sc1
  s_waitcnt vmcnt(0)
  s_barrier
  s_cmp_lg_u32 s5, 4
  s_cbranch_scc1 L_NOP3
  s_mov_b64 exec, 0xffff
  buffer_store_dwordx2 v[250:251], v255, s[60:63], 0 offen sc1
  s_mov_b64 exec, -1
L_NOP3:
  s_lshl_b32 s8, s5, 13
  v_add_u32 v252, s8, v1
  s_lshl_b32 s8, s66, 13
  s_lshl_b32 s9, s74, 11
  s_add_u32 s8, s8, s9
  v_add_u32 v253, s8, v1
  s_mul_i32 s8, s66, 147456
  s_mul_i32 s9, s7, 18432
  s_add_u32 s65, s65, s8
  s_add_u32 s65, s65, s9
  v_and_b32 v244, 3, v0
  v_lshlrev_b32 v244, 3, v244
  s_mov_b32 s12, 0
  s_mov_b64 exec, 15
POLL_47:
  v_mov_b32 v246, 0
  v_mov_b32 v247, 0
  buffer_atomic_or_x2 v[246:247], v244, s[60:63], s65 offen sc0 sc1
  s_add_u32 s12, s12, 1
  s_waitcnt vmcnt(0)
  v_cmp_ne_u64 vcc, s[70:71], v[246:247]
  s_cbranch_vccz POLLD_48
  s_cmp_lt_u32 s12, 0x200000
  s_cbranch_scc1 POLL_47
POLLD_48:
  s_mov_b64 exec, -1
  buffer_load_dwordx4 v[16:19], v1, s[60:63], s64 offen offset:0 sc0 sc1
  buffer_load_dwordx4 v[20:23], v1, s[60:63], s64 offen offset:1024 sc0 sc1
  buffer_load_dwordx4 v[24:27], v1, s[60:63], s64 offen offset:2048 sc0 sc1
  buffer_load_dwordx4 v[28:31], v1, s[60:63], s64 offen offset:3072 sc0 sc1
  s_add_u32 s64, s64, 4096
  buffer_load_dwordx4 v[32:35], v1, s[60:63], s64 offen offset:0 sc0 sc1
  buffer_load_dwordx4 v[36:39], v1, s[60:63], s64 offen offset:1024 sc0 sc1
  buffer_load_dwordx4 v[40:43], v1, s[60:63], s64 offen offset:2048 sc0 sc1
  buffer_load_dwordx4 v[44:47], v1, s[60:63], s64 offen offset:3072 sc0 sc1
  s_add_u32 s64, s64, 4096
  buffer_load_dwordx4 v[48:51], v1, s[60:63], s64 offen offset:0 sc0 sc1
  buffer_load_dwordx4 v[52:55], v1, s[60:63], s64 offen offset:1024 sc0 sc1
  buffer_load_dwordx4 v[56:59], v1, s[60:63], s64 offen offset:2048 sc0 sc1
  buffer_load_dwordx4 v[60:63], v1, s[60:63], s64 offen offset:3072 sc0 sc1
  s_add_u32 s64, s64, 4096
  buffer_load_dwordx4 v[64:67], v1, s[60:63], s64 offen offset:0 sc0 sc1
  buffer_load_dwordx4 v[68:71], v1, s[60:63], s64 offen offset:1024 sc0 sc1
  buffer_load_dwordx4 v[72:75], v1, s[60:63], s64 offen offset:2048 sc0 sc1
  buffer_load_dwordx4 v[76:79], v1, s[60:63], s64 offen offset:3072 sc0 sc1
  s_lshl_b32 s10, s66, 1
  s_lshr_b32 s11, s74, 1
  s_add_u32 s10, s10, s11
  s_lshl_b32 s8, s67, 4
  s_add_u32 s8, s8, s96
  s_lshl_b32 s8, s8, 2
  s_add_u32 s8, s8, s10
  s_lshl_b32 s8, s8, 1
  s_and_b32 s9, s74, 1
  s_add_u32 s8, s8, s9
  s_lshl_b32 s64, s8, 14
  s_add_u32 s64, s64, 0xe00000
  s_mul_i32 s65, s8, 1152
  s_add_u32 s65, s65, 0x2800000
  s_lshl_b32 s11, s97, 3
  s_add_u32 s11, s11, s65
  s_waitcnt vmcnt(15)
  v_mfma_f32_32x32x16_bf16 v[80:95], v[112:115], v[16:19], 0
  v_mfma_f32_32x32x16_bf16 v[96:111], v[116:119], v[16:19], 0
  s_waitcnt vmcnt(14)
  v_mfma_f32_32x32x16_bf16 v[80:95], v[120:123], v[20:23], v[80:95]
  v_mfma_f32_32x32x16_bf16 v[96:111], v[124:127], v[20:23], v[96:111]
  s_waitcnt vmcnt(13)
  v_mfma_f32_32x32x16_bf16 v[80:95], v[128:131], v[24:27], v[80:95]
  v_mfma_f32_32x32x16_bf16 v[96:111], v[132:135], v[24:27], v[96:111]
  s_waitcnt vmcnt(12)
  v_mfma_f32_32x32x16_bf16 v[80:95], v[136:139], v[28:31], v[80:95]
  v_mfma_f32_32x32x16_bf16 v[96:111], v[140:143], v[28:31], v[96:111]
  s_waitcnt vmcnt(11)
  v_mfma_f32_32x32x16_bf16 v[80:95], v[144:147], v[32:35], v[80:95]
  v_mfma_f32_32x32x16_bf16 v[96:111], v[148:151], v[32:35], v[96:111]
  s_waitcnt vmcnt(10)
  v_mfma_f32_32x32x16_bf16 v[80:95], v[152:155], v[36:39], v[80:95]
  v_mfma_f32_32x32x16_bf16 v[96:111], v[156:159], v[36:39], v[96:111]
  s_waitcnt vmcnt(9)
  v_mfma_f32_32x32x16_bf16 v[80:95], v[160:163], v[40:43], v[80:95]
  v_mfma_f32_32x32x16_bf16 v[96:111], v[164:167], v[40:43], v[96:111]
  s_waitcnt vmcnt(8)
  v_mfma_f32_32x32x16_bf16 v[80:95], v[168:171], v[44:47], v[80:95]
  v_mfma_f32_32x32x16_bf16 v[96:111], v[172:175], v[44:47], v[96:111]
  s_waitcnt vmcnt(7)
  v_mfma_f32_32x32x16_bf16 v[80:95], v[176:179], v[48:51], v[80:95]
  v_mfma_f32_32x32x16_bf16 v[96:111], v[180:183], v[48:51], v[96:111]
  s_waitcnt vmcnt(6)
  v_mfma_f32_32x32x16_bf16 v[80:95], v[184:187], v[52:55], v[80:95]
  v_mfma_f32_32x32x16_bf16 v[96:111], v[188:191], v[52:55], v[96:111]
  s_waitcnt vmcnt(5)
  v_mfma_f32_32x32x16_bf16 v[80:95], v[192:195], v[56:59], v[80:95]
  v_mfma_f32_32x32x16_bf16 v[96:111], v[196:199], v[56:59], v[96:111]
  s_waitcnt vmcnt(4)
  v_mfma_f32_32x32x16_bf16 v[80:95], v[200:203], v[60:63], v[80:95]
  v_mfma_f32_32x32x16_bf16 v[96:111], v[204:207], v[60:63], v[96:111]
  s_waitcnt vmcnt(3)
  v_mfma_f32_32x32x16_bf16 v[80:95], v[208:211], v[64:67], v[80:95]
  v_mfma_f32_32x32x16_bf16 v[96:111], v[212:215], v[64:67], v[96:111]
  s_waitcnt vmcnt(2)
  v_mfma_f32_32x32x16_bf16 v[80:95], v[216:219], v[68:71], v[80:95]
  v_mfma_f32_32x32x16_bf16 v[96:111], v[220:223], v[68:71], v[96:111]
  s_waitcnt vmcnt(1)
  v_mfma_f32_32x32x16_bf16 v[80:95], v[224:227], v[72:75], v[80:95]
  v_mfma_f32_32x32x16_bf16 v[96:111], v[228:231], v[72:75], v[96:111]
  s_waitcnt vmcnt(0)
  v_mfma_f32_32x32x16_bf16 v[80:95], v[232:235], v[76:79], v[80:95]
  v_mfma_f32_32x32x16_bf16 v[96:111], v[236:239], v[76:79], v[96:111]
  v_mov_b32 v51, s70
  v_mov_b32 v55, s70
  v_mov_b32 v58, 0
  v_mov_b32 v59, s70
  v_and_b32 v24, 31, v0
  v_lshrrev_b32 v25, 5, v0
  v_lshlrev_b32 v24, 11, v24
  v_lshl_add_u32 v254, v25, 3, v24
  s_nop 2
  ds_write_b128 v252, v[80:83] offset:0
  ds_write_b128 v252, v[84:87] offset:1024
  ds_write_b128 v252, v[88:91] offset:2048
  ds_write_b128 v252, v[92:95] offset:3072
  ds_write_b128 v252, v[96:99] offset:4096
  ds_write_b128 v252, v[100:103] offset:5120
  ds_write_b128 v252, v[104:107] offset:6144
  ds_write_b128 v252, v[108:111] offset:7168
  s_waitcnt lgkmcnt(0)
  s_barrier
  ds_read_b128 v[16:19], v253 offset:0
  ds_read_b128 v[20:23], v253 offset:1024
  ds_read_b128 v[24:27], v253 offset:16384
  ds_read_b128 v[28:31], v253 offset:17408
  ds_read_b128 v[32:35], v253 offset:32768
  ds_read_b128 v[36:39], v253 offset:33792
  ds_read_b128 v[40:43], v253 offset:49152
  ds_read_b128 v[44:47], v253 offset:50176
  s_waitcnt lgkmcnt(4)
  v_add_f32 v16, v16, v24
  v_add_f32 v17, v17, v25
  v_add_f32 v18, v18, v26
  v_add_f32 v19, v19, v27
  v_add_f32 v20, v20, v28
  v_add_f32 v21, v21, v29
  v_add_f32 v22, v22, v30
  v_add_f32 v23, v23, v31
  s_waitcnt lgkmcnt(0)
  v_add_f32 v32, v32, v40
  v_add_f32 v33, v33, v41
  v_add_f32 v34, v34, v42
  v_add_f32 v35, v35, v43
  v_add_f32 v36, v36, v44
  v_add_f32 v37, v37, v45
  v_add_f32 v38, v38, v46
  v_add_f32 v39, v39, v47
  v_add_f32 v48, v16, v32
  v_add_f32 v49, v17, v33
  v_add_f32 v50, v18, v34
  v_add_f32 v52, v19, v35
  v_add_f32 v53, v20, v36
  v_add_f32 v54, v21, v37
  v_add_f32 v56, v22, v38
  v_add_f32 v57, v23, v39
  s_cmp_eq_u32 s10, s97
  s_cbranch_scc1 L_OWN
  s_lshl_b32 s8, s97, 12
  s_add_u32 s8, s8, s64
  buffer_store_dwordx4 v[48:51], v1, s[60:63], s8 offen offset:0 sc1
  buffer_store_dwordx4 v[52:55], v1, s[60:63], s8 offen offset:1024 sc1
  buffer_store_dwordx4 v[56:59], v1, s[60:63], s8 offen offset:2048 sc1
  v_mov_b32 v255, s11
  s_mov_b64 exec, 1
  buffer_store_dwordx2 v[250:251], v255, s[60:63], 0 offen sc1
  s_mov_b64 exec, -1
  s_branch L_FIN
L_OWN:
  v_mov_b32 v255, s11
  s_mov_b64 exec, 1
  buffer_store_dwordx2 v[250:251], v255, s[60:63], 0 offen sc1
  s_mov_b64 exec, -1
  s_lshl_b32 s10, s67, 1
  s_add_u32 s10, s10, s66
  s_lshl_b32 s10, s10, 16
  s_lshl_b32 s9, s96, 7
  s_add_u32 s10, s10, s9
  s_lshl_b32 s9, s74, 5
  s_add_u32 s10, s10, s9
  v_and_b32 v244, 3, v0
  v_lshlrev_b32 v244, 3, v244
  s_mov_b32 s12, 0
  s_mov_b64 exec, 15
POLL_49:
  v_mov_b32 v246, 0
  v_mov_b32 v247, 0
  buffer_atomic_or_x2 v[246:247], v244, s[60:63], s65 offen sc0 sc1
  s_add_u32 s12, s12, 1
  s_waitcnt vmcnt(0)
  v_cmp_ne_u64 vcc, s[70:71], v[246:247]
  s_cbranch_vccz POLLD_50
  s_cmp_lt_u32 s12, 0x200000
  s_cbranch_scc1 POLL_49
POLLD_50:
  s_mov_b64 exec, -1
  s_mov_b32 s12, 0
L_OPL:
  s_add_u32 s8, s97, 1
  s_and_b32 s8, s8, 3
  s_lshl_b32 s8, s8, 12
  s_add_u32 s8, s8, s64
  buffer_load_dwordx4 v[60:63], v1, s[60:63], s8 offen offset:0 sc0 sc1
  buffer_load_dwordx4 v[64:67], v1, s[60:63], s8 offen offset:1024 sc0 sc1
  buffer_load_dwordx4 v[68:71], v1, s[60:63], s8 offen offset:2048 sc0 sc1
  s_add_u32 s8, s97, 2
  s_and_b32 s8, s8, 3
  s_lshl_b32 s8, s8, 12
  s_add_u32 s8, s8, s64
  buffer_load_dwordx4 v[72:75], v1, s[60:63], s8 offen offset:0 sc0 sc1
  buffer_load_dwordx4 v[76:79], v1, s[60:63], s8 offen offset:1024 sc0 sc1
  buffer_load_dwordx4 v[80:83], v1, s[60:63], s8 offen offset:2048 sc0 sc1
  s_add_u32 s8, s97, 3
  s_and_b32 s8, s8, 3
  s_lshl_b32 s8, s8, 12
  s_add_u32 s8, s8, s64
  buffer_load_dwordx4 v[84:87], v1, s[60:63], s8 offen offset:0 sc0 sc1
  buffer_load_dwordx4 v[88:91], v1, s[60:63], s8 offen offset:1024 sc0 sc1
  buffer_load_dwordx4 v[92:95], v1, s[60:63], s8 offen offset:2048 sc0 sc1
  s_add_u32 s12, s12, 1
  s_waitcnt vmcnt(0)
  v_min3_u32 v16, v63, v67, v71
  v_max3_u32 v17, v63, v67, v71
  v_min3_u32 v16, v75, v79, v16
  v_max3_u32 v17, v75, v79, v17
  v_min3_u32 v16, v83, v87, v16
  v_max3_u32 v17, v83, v87, v17
  v_min3_u32 v16, v91, v95, v16
  v_max3_u32 v17, v91, v95, v17
  v_xor_b32 v16, s70, v16
  v_xor_b32 v17, s70, v17
  v_or_b32 v16, v16, v17
  v_cmp_ne_u32 vcc, 0, v16
  s_cbranch_vccz L_OPD
  s_cmp_lt_u32 s12, 0x200000
  s_cbranch_scc1 L_OPL
L_OPD:
  v_add_f32 v48, v48, v60
  v_add_f32 v49, v49, v61
  v_add_f32 v50, v50, v62
  v_add_f32 v52, v52, v64
  v_add_f32 v53, v53, v65
  v_add_f32 v54, v54, v66
  v_add_f32 v56, v56, v68
  v_add_f32 v57, v57, v69
  v_add_f32 v48, v48, v72
  v_add_f32 v49, v49, v73
  v_add_f32 v50, v50, v74
  v_add_f32 v52, v52, v76
  v_add_f32 v53, v53, v77
  v_add_f32 v54, v54, v78
  v_add_f32 v56, v56, v80
  v_add_f32 v57, v57, v81
  v_add_f32 v48, v48, v84
  v_add_f32 v49, v49, v85
  v_add_f32 v50, v50, v86
  v_add_f32 v52, v52, v88
  v_add_f32 v53, v53, v89
  v_add_f32 v54, v54, v90
  v_add_f32 v56, v56, v92
  v_add_f32 v57, v57, v93
  v_cvt_pk_bf16_f32 v16, v48, v49
  v_cvt_pk_bf16_f32 v17, v50, v52
  v_cvt_pk_bf16_f32 v18, v53, v54
  v_cvt_pk_bf16_f32 v19, v56, v57
  buffer_store_dwordx2 v[16:17], v254, s[52:55], s10 offen
  buffer_store_dwordx2 v[18:19], v254, s[52:55], s10 offen offset:16
L_FIN:
L_END:
  s_endpgm
RS_7:
  s_call_b64 s[78:79], L_RARE1
  s_branch RB_8
RS_9:
  s_call_b64 s[78:79], L_RARE0
  s_branch RB_10
RS_11:
  s_call_b64 s[78:79], L_RARE1
  s_branch RB_12
RS_13:
  s_call_b64 s[78:79], L_RARE0
  s_branch RB_14
RS_15:
  s_call_b64 s[78:79], L_RARE1
  s_branch RB_16
RS_17:
  s_call_b64 s[78:79], L_RARE0
  s_branch RB_18
RS_19:
  s_call_b64 s[78:79], L_RARE1
  s_branch RB_20
RS_21:
  s_call_b64 s[78:79], L_RARE0
  s_branch RB_22
RS_23:
  s_call_b64 s[78:79], L_RARE1
  s_branch RB_24
RS_25:
  s_call_b64 s[78:79], L_RARE0
  s_branch RB_26
RS_27:
  s_call_b64 s[78:79], L_RARE1
  s_branch RB_28
RS_29:
  s_call_b64 s[78:79], L_RARE0
  s_branch RB_30
RS_31:
  s_call_b64 s[78:79], L_RARE1
  s_branch RB_32
RS_33:
  s_call_b64 s[78:79], L_RARE0
  s_branch RB_34
RS_35:
  s_call_b64 s[78:79], L_RARE1
  s_branch RB_36
L_RARE0:
  s_nop 15
  v_max3_f32 v248, v176, v177, v178
  v_max3_f32 v249, v179, v180, v181
  v_max3_f32 v248, v182, v183, v248
  v_max_f32 v248, v248, v249
  v_mov_b32 v249, v248
  s_nop 1
  v_permlane16_swap_b32 v248, v249
  s_nop 1
  v_max_f32 v248, v248, v249
  v_mov_b32 v249, v248
  s_nop 1
  v_permlane32_swap_b32 v248, v249
  s_nop 1
  v_max_f32 v248, v248, v249
  v_add_f32 v248, 0x41100000, v248
  v_max_f32 v248, 0, v248
  v_ceil_f32 v248, v248
  v_sub_f32 v249, 0, v248
  v_exp_f32 v249, v249
  v_sub_f32 v176, v176, v248
  v_sub_f32 v177, v177, v248
  v_sub_f32 v178, v178, v248
  v_sub_f32 v179, v179, v248
  v_sub_f32 v180, v180, v248
  v_sub_f32 v181, v181, v248
  v_sub_f32 v182, v182, v248
  v_sub_f32 v183, v183, v248
  v_sub_f32 v192, v192, v248
  v_sub_f32 v193, v193, v248
  v_sub_f32 v194, v194, v248
  v_sub_f32 v195, v195, v248
  v_sub_f32 v196, v196, v248
  v_sub_f32 v197, v197, v248
  v_sub_f32 v198, v198, v248
  v_sub_f32 v199, v199, v248
  v_sub_f32 v224, v224, v248
  v_sub_f32 v225, v225, v248
  v_sub_f32 v226, v226, v248
  v_sub_f32 v227, v227, v248
  v_mul_f32 v112, v112, v249
  v_mul_f32 v113, v113, v249
  v_mul_f32 v114, v114, v249
  v_mul_f32 v115, v115, v249
  v_mul_f32 v116, v116, v249
  v_mul_f32 v117, v117, v249
  v_mul_f32 v118, v118, v249
  v_mul_f32 v119, v119, v249
  v_mul_f32 v120, v120, v249
  v_mul_f32 v121, v121, v249
  v_mul_f32 v122, v122, v249
  v_mul_f32 v123, v123, v249
  v_mul_f32 v124, v124, v249
  v_mul_f32 v125, v125, v249
  v_mul_f32 v126, v126, v249
  v_mul_f32 v127, v127, v249
  v_mul_f32 v128, v128, v249
  v_mul_f32 v129, v129, v249
  v_mul_f32 v130, v130, v249
  v_mul_f32 v131, v131, v249
  v_mul_f32 v132, v132, v249
  v_mul_f32 v133, v133, v249
  v_mul_f32 v134, v134, v249
  v_mul_f32 v135, v135, v249
  v_mul_f32 v136, v136, v249
  v_mul_f32 v137, v137, v249
  v_mul_f32 v138, v138, v249
  v_mul_f32 v139, v139, v249
  v_mul_f32 v140, v140, v249
  v_mul_f32 v141, v141, v249
  v_mul_f32 v142, v142, v249
  v_mul_f32 v143, v143, v249
  v_mul_f32 v232, v232, v249
  v_mul_f32 v233, v233, v249
  v_mul_f32 v234, v234, v249
  v_mul_f32 v235, v235, v249
  v_max3_f32 v248, v184, v185, v186
  v_max3_f32 v249, v187, v188, v189
  v_max3_f32 v248, v190, v191, v248
  v_max_f32 v248, v248, v249
  v_mov_b32 v249, v248
  s_nop 1
  v_permlane16_swap_b32 v248, v249
  s_nop 1
  v_max_f32 v248, v248, v249
  v_mov_b32 v249, v248
  s_nop 1
  v_permlane32_swap_b32 v248, v249
  s_nop 1
  v_max_f32 v248, v248, v249
  v_add_f32 v248, 0x41100000, v248
  v_max_f32 v248, 0, v248
  v_ceil_f32 v248, v248
  v_sub_f32 v249, 0, v248
  v_exp_f32 v249, v249
  v_sub_f32 v184, v184, v248
  v_sub_f32 v185, v185, v248
  v_sub_f32 v186, v186, v248
  v_sub_f32 v187, v187, v248
  v_sub_f32 v188, v188, v248
  v_sub_f32 v189, v189, v248
  v_sub_f32 v190, v190, v248
  v_sub_f32 v191, v191, v248
  v_sub_f32 v200, v200, v248
  v_sub_f32 v201, v201, v248
  v_sub_f32 v202, v202, v248
  v_sub_f32 v203, v203, v248
  v_sub_f32 v204, v204, v248
  v_sub_f32 v205, v205, v248
  v_sub_f32 v206, v206, v248
  v_sub_f32 v207, v207, v248
  v_sub_f32 v228, v228, v248
  v_sub_f32 v229, v229, v248
  v_sub_f32 v230, v230, v248
  v_sub_f32 v231, v231, v248
  v_mul_f32 v144, v144, v249
  v_mul_f32 v145, v145, v249
  v_mul_f32 v146, v146, v249
  v_mul_f32 v147, v147, v249
  v_mul_f32 v148, v148, v249
  v_mul_f32 v149, v149, v249
  v_mul_f32 v150, v150, v249
  v_mul_f32 v151, v151, v249
  v_mul_f32 v152, v152, v249
  v_mul_f32 v153, v153, v249
  v_mul_f32 v154, v154, v249
  v_mul_f32 v155, v155, v249
  v_mul_f32 v156, v156, v249
  v_mul_f32 v157, v157, v249
  v_mul_f32 v158, v158, v249
  v_mul_f32 v159, v159, v249
  v_mul_f32 v160, v160, v249
  v_mul_f32 v161, v161, v249
  v_mul_f32 v162, v162, v249
  v_mul_f32 v163, v163, v249
  v_mul_f32 v164, v164, v249
  v_mul_f32 v165, v165, v249
  v_mul_f32 v166, v166, v249
  v_mul_f32 v167, v167, v249
  v_mul_f32 v168, v168, v249
  v_mul_f32 v169, v169, v249
  v_mul_f32 v170, v170, v249
  v_mul_f32 v171, v171, v249
  v_mul_f32 v172, v172, v249
  v_mul_f32 v173, v173, v249
  v_mul_f32 v174, v174, v249
  v_mul_f32 v175, v175, v249
  v_mul_f32 v236, v236, v249
  v_mul_f32 v237, v237, v249
  v_mul_f32 v238, v238, v249
  v_mul_f32 v239, v239, v249
  v_exp_f32 v14, v176
  v_exp_f32 v15, v177
  s_nop 0
  v_cvt_pk_bf16_f32 v208, v14, v15
  v_exp_f32 v14, v178
  v_exp_f32 v15, v179
  s_nop 0
  v_cvt_pk_bf16_f32 v209, v14, v15
  v_exp_f32 v14, v180
  v_exp_f32 v15, v181
  s_nop 0
  v_cvt_pk_bf16_f32 v210, v14, v15
  v_exp_f32 v14, v182
  v_exp_f32 v15, v183
  s_nop 0
  v_cvt_pk_bf16_f32 v211, v14, v15
  v_exp_f32 v14, v184
  v_exp_f32 v15, v185
  s_nop 0
  v_cvt_pk_bf16_f32 v212, v14, v15
  v_exp_f32 v14, v186
  v_exp_f32 v15, v187
  s_nop 0
  v_cvt_pk_bf16_f32 v213, v14, v15
  v_exp_f32 v14, v188
  v_exp_f32 v15, v189
  s_nop 0
  v_cvt_pk_bf16_f32 v214, v14, v15
  v_exp_f32 v14, v190
  v_exp_f32 v15, v191
  s_nop 0
  v_cvt_pk_bf16_f32 v215, v14, v15
  s_nop 1
  s_setpc_b64 s[78:79]
L_RARE1:
  s_nop 15
  v_max3_f32 v248, v192, v193, v194
  v_max3_f32 v249, v195, v196, v197
  v_max3_f32 v248, v198, v199, v248
  v_max_f32 v248, v248, v249
  v_mov_b32 v249, v248
  s_nop 1
  v_permlane16_swap_b32 v248, v249
  s_nop 1
  v_max_f32 v248, v248, v249
  v_mov_b32 v249, v248
  s_nop 1
  v_permlane32_swap_b32 v248, v249
  s_nop 1
  v_max_f32 v248, v248, v249
  v_add_f32 v248, 0x41100000, v248
  v_max_f32 v248, 0, v248
  v_ceil_f32 v248, v248
  v_sub_f32 v249, 0, v248
  v_exp_f32 v249, v249
  v_sub_f32 v192, v192, v248
  v_sub_f32 v193, v193, v248
  v_sub_f32 v194, v194, v248
  v_sub_f32 v195, v195, v248
  v_sub_f32 v196, v196, v248
  v_sub_f32 v197, v197, v248
  v_sub_f32 v198, v198, v248
  v_sub_f32 v199, v199, v248
  v_sub_f32 v176, v176, v248
  v_sub_f32 v177, v177, v248
  v_sub_f32 v178, v178, v248
  v_sub_f32 v179, v179, v248
  v_sub_f32 v180, v180, v248
  v_sub_f32 v181, v181, v248
  v_sub_f32 v182, v182, v248
  v_sub_f32 v183, v183, v248
  v_sub_f32 v224, v224, v248
  v_sub_f32 v225, v225, v248
  v_sub_f32 v226, v226, v248
  v_sub_f32 v227, v227, v248
  v_mul_f32 v112, v112, v249
  v_mul_f32 v113, v113, v249
  v_mul_f32 v114, v114, v249
  v_mul_f32 v115, v115, v249
  v_mul_f32 v116, v116, v249
  v_mul_f32 v117, v117, v249
  v_mul_f32 v118, v118, v249
  v_mul_f32 v119, v119, v249
  v_mul_f32 v120, v120, v249
  v_mul_f32 v121, v121, v249
  v_mul_f32 v122, v122, v249
  v_mul_f32 v123, v123, v249
  v_mul_f32 v124, v124, v249
  v_mul_f32 v125, v125, v249
  v_mul_f32 v126, v126, v249
  v_mul_f32 v127, v127, v249
  v_mul_f32 v128, v128, v249
  v_mul_f32 v129, v129, v249
  v_mul_f32 v130, v130, v249
  v_mul_f32 v131, v131, v249
  v_mul_f32 v132, v132, v249
  v_mul_f32 v133, v133, v249
  v_mul_f32 v134, v134, v249
  v_mul_f32 v135, v135, v249
  v_mul_f32 v136, v136, v249
  v_mul_f32 v137, v137, v249
  v_mul_f32 v138, v138, v249
  v_mul_f32 v139, v139, v249
  v_mul_f32 v140, v140, v249
  v_mul_f32 v141, v141, v249
  v_mul_f32 v142, v142, v249
  v_mul_f32 v143, v143, v249
  v_mul_f32 v232, v232, v249
  v_mul_f32 v233, v233, v249
  v_mul_f32 v234, v234, v249
  v_mul_f32 v235, v235, v249
  v_max3_f32 v248, v200, v201, v202
  v_max3_f32 v249, v203, v204, v205
  v_max3_f32 v248, v206, v207, v248
  v_max_f32 v248, v248, v249
  v_mov_b32 v249, v248
  s_nop 1
  v_permlane16_swap_b32 v248, v249
  s_nop 1
  v_max_f32 v248, v248, v249
  v_mov_b32 v249, v248
  s_nop 1
  v_permlane32_swap_b32 v248, v249
  s_nop 1
  v_max_f32 v248, v248, v249
  v_add_f32 v248, 0x41100000, v248
  v_max_f32 v248, 0, v248
  v_ceil_f32 v248, v248
  v_sub_f32 v249, 0, v248
  v_exp_f32 v249, v249
  v_sub_f32 v200, v200, v248
  v_sub_f32 v201, v201, v248
  v_sub_f32 v202, v202, v248
  v_sub_f32 v203, v203, v248
  v_sub_f32 v204, v204, v248
  v_sub_f32 v205, v205, v248
  v_sub_f32 v206, v206, v248
  v_sub_f32 v207, v207, v248
  v_sub_f32 v184, v184, v248
  v_sub_f32 v185, v185, v248
  v_sub_f32 v186, v186, v248
  v_sub_f32 v187, v187, v248
  v_sub_f32 v188, v188, v248
  v_sub_f32 v189, v189, v248
  v_sub_f32 v190, v190, v248
  v_sub_f32 v191, v191, v248
  v_sub_f32 v228, v228, v248
  v_sub_f32 v229, v229, v248
  v_sub_f32 v230, v230, v248
  v_sub_f32 v231, v231, v248
  v_mul_f32 v144, v144, v249
  v_mul_f32 v145, v145, v249
  v_mul_f32 v146, v146, v249
  v_mul_f32 v147, v147, v249
  v_mul_f32 v148, v148, v249
  v_mul_f32 v149, v149, v249
  v_mul_f32 v150, v150, v249
  v_mul_f32 v151, v151, v249
  v_mul_f32 v152, v152, v249
  v_mul_f32 v153, v153, v249
  v_mul_f32 v154, v154, v249
  v_mul_f32 v155, v155, v249
  v_mul_f32 v156, v156, v249
  v_mul_f32 v157, v157, v249
  v_mul_f32 v158, v158, v249
  v_mul_f32 v159, v159, v249
  v_mul_f32 v160, v160, v249
  v_mul_f32 v161, v161, v249
  v_mul_f32 v162, v162, v249
  v_mul_f32 v163, v163, v249
  v_mul_f32 v164, v164, v249
  v_mul_f32 v165, v165, v249
  v_mul_f32 v166, v166, v249
  v_mul_f32 v167, v167, v249
  v_mul_f32 v168, v168, v249
  v_mul_f32 v169, v169, v249
  v_mul_f32 v170, v170, v249
  v_mul_f32 v171, v171, v249
  v_mul_f32 v172, v172, v249
  v_mul_f32 v173, v173, v249
  v_mul_f32 v174, v174, v249
  v_mul_f32 v175, v175, v249
  v_mul_f32 v236, v236, v249
  v_mul_f32 v237, v237, v249
  v_mul_f32 v238, v238, v249
  v_mul_f32 v239, v239, v249
  v_exp_f32 v14, v192
  v_exp_f32 v15, v193
  s_nop 0
  v_cvt_pk_bf16_f32 v216, v14, v15
  v_exp_f32 v14, v194
  v_exp_f32 v15, v195
  s_nop 0
  v_cvt_pk_bf16_f32 v217, v14, v15
  v_exp_f32 v14, v196
  v_exp_f32 v15, v197
  s_nop 0
  v_cvt_pk_bf16_f32 v218, v14, v15
  v_exp_f32 v14, v198
  v_exp_f32 v15, v199
  s_nop 0
  v_cvt_pk_bf16_f32 v219, v14, v15
  v_exp_f32 v14, v200
  v_exp_f32 v15, v201
  s_nop 0
  v_cvt_pk_bf16_f32 v220, v14, v15
  v_exp_f32 v14, v202
  v_exp_f32 v15, v203
  s_nop 0
  v_cvt_pk_bf16_f32 v221, v14, v15
  v_exp_f32 v14, v204
  v_exp_f32 v15, v205
  s_nop 0
  v_cvt_pk_bf16_f32 v222, v14, v15
  v_exp_f32 v14, v206
  v_exp_f32 v15, v207
  s_nop 0
  v_cvt_pk_bf16_f32 v223, v14, v15
  s_nop 1
  s_setpc_b64 s[78:79]
L_CODE_END:
.section .rodata,"a"
.p2align 6
.amdhsa_kernel standalone__sliding_block_cached__sampling_kernel
  .amdhsa_next_free_vgpr 256
  .amdhsa_next_free_sgpr 102
  .amdhsa_accum_offset 256
  .amdhsa_group_segment_fixed_size 0
  .amdhsa_kernarg_size 64
  .amdhsa_user_sgpr_count 2
  .amdhsa_user_sgpr_kernarg_segment_ptr 1
  .amdhsa_system_sgpr_workgroup_id_x 1
.end_amdhsa_kernel
```
